```python
import torch

def _softmax(x, axis=-1):
    return torch.softmax(x, dim=axis)
def _gelu(x):
    return torch.nn.functional.gelu(x, approximate="tanh")
def _silu(x):
    return torch.nn.functional.silu(x)
def _sigmoid(x):
    return torch.sigmoid(x)
def _layernorm(x, axis=-1, eps=1e-5):
    m = x.mean(dim=axis, keepdim=True)
    v = x.var(dim=axis, keepdim=True, unbiased=False)
    return (x - m) / torch.sqrt(v + eps)
def _scatter_add(tgt, idx, src, axis=0):
    return tgt.clone().index_add_(axis, idx, src)
def _segment_sum(src, seg, n):
    out = torch.zeros((n,) + src.shape[1:], dtype=src.dtype)
    return out.index_add_(0, seg, src)
def _pad(x, pw):
    flat = tuple(v for pair in reversed(pw) for v in pair)
    return torch.nn.functional.pad(x, flat)

kernel_name = 'sequential_preLN__sliding_block_cached__glu_gated_glu__decode'

def setup_inputs():

    _w = (lambda a: (lambda t: t.to(torch.bfloat16) if t.is_floating_point() else t)(torch.as_tensor(a)))
    def _A_setup():
        B, Sq, D = 8, 1, 1024
        Hq, Hkv, Sk, Dh = 32, 4, 4096, 128
        assert Hq % Hkv == 0, (Hq, Hkv)
        return {
            "x": _w((lambda *s: torch.randn(*s, dtype=torch.bfloat16) * 0.05)(B, Sq, D)),
            "k_cache": _w((lambda *s: torch.randn(*s, dtype=torch.bfloat16) * 3.2)(B, Hkv, Sk, Dh)),
            "v_cache": _w((lambda *s: torch.randn(*s, dtype=torch.bfloat16) * 0.4)(B, Hkv, Sk, Dh)),
            "wq": _w((lambda *s: torch.randn(*s, dtype=torch.bfloat16) * 3.2)(D, Hq * Dh) * (D ** -0.5)),
            "wo": _w((lambda *s: torch.randn(*s, dtype=torch.bfloat16) * 0.4)(Hq * Dh, D) * ((Hq * Dh) ** -0.5)),
        }
    _A_in = _A_setup()

    def _B_setup():
        B, S, D, F = 8, 1, 1024, 3584
        return {
            "x": _w((lambda *s: torch.randn(*s, dtype=torch.bfloat16) * 0.05)(B, S, D)),
            "w_gate": _w((lambda *s: torch.randn(*s, dtype=torch.bfloat16) * 0.05)(D, F)),
            "w_up": _w((lambda *s: torch.randn(*s, dtype=torch.bfloat16) * 0.05)(D, F)),
            "w_down": _w((lambda *s: torch.randn(*s, dtype=torch.bfloat16) * 0.05)(F, D)),
        }
    _B_in = _B_setup()

    return {
        "A_x": _A_in["x"],
        "A_k_cache": _A_in["k_cache"],
        "A_v_cache": _A_in["v_cache"],
        "A_wq": _A_in["wq"],
        "A_wo": _A_in["wo"],
        "B_x": _B_in["x"],
        "B_w_gate": _B_in["w_gate"],
        "B_w_up": _B_in["w_up"],
        "B_w_down": _B_in["w_down"],
    }

def reference(A_x, A_k_cache, A_v_cache, A_wq, A_wo, B_x, B_w_gate, B_w_up, B_w_down):
    def _A_ref(x, k_cache, v_cache, wq, wo):
        B, Sq, D = x.shape
        Hq, Dh = 32, 128
        Hkv, Sk = k_cache.shape[1], k_cache.shape[2]
        W = min(4096, max(256, Sk // 4))
        rep = Hq // Hkv
        q = (lambda x, *d: x.permute(*d))((x @ wq).reshape(B, Sq, Hq, Dh), 0, 2, 1, 3)
        k = (lambda x, n, axis: torch.repeat_interleave(x, n, dim=axis))(k_cache[:, :, Sk - W:, :], rep, axis=1)
        v = (lambda x, n, axis: torch.repeat_interleave(x, n, dim=axis))(v_cache[:, :, Sk - W:, :], rep, axis=1)
        scores = torch.einsum("bhqd,bhkd->bhqk", q, k) * (Dh ** -0.5)
        p = _softmax(scores, axis=-1)
        o = torch.einsum("bhqk,bhkd->bhqd", p, v)
        return (lambda x, *d: x.permute(*d))(o, 0, 2, 1, 3).reshape(B, Sq, Hq * Dh) @ wo

    def _B_ref(x, w_gate, w_up, w_down):
        g = torch.einsum("bsd,df->bsf", x, w_gate)
        u = torch.einsum("bsd,df->bsf", x, w_up)
        h = _sigmoid(g) * u
        return torch.einsum("bsf,fd->bsd", h, w_down)

    x = A_x
    h = x + _A_ref(_layernorm(x, axis=-1), A_k_cache, A_v_cache, A_wq, A_wo)
    h2 = h + _B_ref(_layernorm(h, axis=-1), B_w_gate, B_w_up, B_w_down)
    return h2
```

```asm
; @launch grid=(256,1,1) block=(512,1,1) lds=154112
.amdgcn_target "amdgcn-amd-amdhsa--gfx950"
.text
.globl sequential_preLN__sliding_block_cached__glu_gated_glu__decode_kernel
.p2align 8
.type sequential_preLN__sliding_block_cached__glu_gated_glu__decode_kernel,@function
sequential_preLN__sliding_block_cached__glu_gated_glu__decode_kernel:
    s_cmp_ge_u32 s2, 256
    s_cbranch_scc1 L_end
    s_load_dwordx16 s[4:19], s[0:1], 0
    s_load_dwordx8 s[20:27], s[0:1], 64
    v_lshrrev_b32 v4, 6, v0
    v_and_b32 v1, 63, v0
    v_readfirstlane_b32 s28, v4
    v_and_b32 v2, 15, v1
    v_lshrrev_b32 v3, 4, v1
    s_and_b32 s29, s2, 7
    s_lshr_b32 s30, s2, 4
    v_mov_b32 v19, 0
    s_bitcmp1_b32 s2, 3
    s_cbranch_scc1 L_roleA
    v_bfe_u32 v9, v1, 1, 3
    v_xor_b32 v9, v3, v9
    v_lshlrev_b32 v9, 5, v9
    v_and_b32 v4, 1, v1
    v_lshl_add_u32 v9, v4, 4, v9
    v_mul_u32_u24 v4, 8192, v3
    v_add_u32 v4, v4, v9
    v_xor_b32 v5, 0x80, v4
    v_lshlrev_b32 v18, 4, v1
    s_and_b32 s56, s30, 3
    s_lshr_b32 s53, s30, 2
    s_lshl_b32 s54, s29, 1
    s_add_u32 s54, s54, s53
    s_lshl_b32 s55, s54, 2
    s_add_u32 s55, s55, 1
    s_sub_u32 s54, s54, 2
    s_lshl_b32 s57, s29, 2
    s_add_u32 s57, s57, s53
    s_sub_u32 s57, s57, 8
    s_cmp_ge_u32 s29, 4
    s_cselect_b32 s54, s57, s54
    s_cselect_b32 s53, 2, s53
    s_mul_i32 s57, s54, 43
    s_lshr_b32 s57, s57, 7
    s_mul_i32 s58, s57, 3
    s_sub_u32 s58, s54, s58
    s_lshl_b32 s57, s57, 2
    s_add_u32 s57, s57, s58
    s_min_u32 s58, s58, 1
    s_add_u32 s57, s57, s58
    s_cmp_ge_u32 s53, 2
    s_cselect_b32 s55, s57, s55
    s_lshl_b32 s57, s56, 21
    s_lshl_b32 s53, s55, 8
    s_add_u32 s57, s57, s53
    s_lshl_b32 s82, s28, 11
    s_lshl_b32 s83, s56, 9
    s_add_u32 s83, s83, s82
    s_waitcnt lgkmcnt(0)
    s_mov_b32 s40, s4
    s_and_b32 s41, s5, 0xffff
    s_mov_b32 s42, 0x4000
    s_mov_b32 s43, 0x20000
    s_mov_b32 s32, s10
    s_and_b32 s33, s11, 0xffff
    s_mov_b32 s34, 0x800000
    s_mov_b32 s35, 0x20000
    buffer_load_dwordx4 v[32:35], v18, s[40:43], s82 offen
    buffer_load_dwordx4 v[36:39], v18, s[40:43], s82 offen offset:1024
    buffer_load_dwordx4 v[40:43], v18, s[40:43], s83 offen
    s_mul_i32 s53, s28, 262144
    s_add_u32 s53, s53, s57
    s_mul_i32 s54, s28, 8192
    s_mov_b32 m0, s54
    s_add_u32 s54, s54, 1024
    buffer_load_dwordx4 v4, s[32:35], s53 offen nt lds
    s_add_u32 s53, s53, 32768
    s_mov_b32 m0, s54
    s_add_u32 s54, s54, 1024
    buffer_load_dwordx4 v4, s[32:35], s53 offen nt lds
    s_add_u32 s53, s53, 32768
    s_mov_b32 m0, s54
    s_add_u32 s54, s54, 1024
    buffer_load_dwordx4 v5, s[32:35], s53 offen nt lds
    s_add_u32 s53, s53, 32768
    s_mov_b32 m0, s54
    s_add_u32 s54, s54, 1024
    buffer_load_dwordx4 v5, s[32:35], s53 offen nt lds
    s_add_u32 s53, s53, 32768
    s_mov_b32 m0, s54
    s_add_u32 s54, s54, 1024
    buffer_load_dwordx4 v4, s[32:35], s53 offen nt lds
    s_add_u32 s53, s53, 32768
    s_mov_b32 m0, s54
    s_add_u32 s54, s54, 1024
    buffer_load_dwordx4 v4, s[32:35], s53 offen nt lds
    s_add_u32 s53, s53, 32768
    s_mov_b32 m0, s54
    s_add_u32 s54, s54, 1024
    buffer_load_dwordx4 v5, s[32:35], s53 offen nt lds
    s_add_u32 s53, s53, 32768
    s_mov_b32 m0, s54
    s_nop 0
    buffer_load_dwordx4 v5, s[32:35], s53 offen nt lds
    s_mov_b32 s36, s26
    s_and_b32 s37, s27, 0xffff
    s_mov_b32 s38, 0x800000
    s_mov_b32 s39, 0x20000
    buffer_load_dword v44, v19, s[36:39], 0 offen sc1
    s_mov_b32 s52, 0x200000
    s_mov_b32 s50, 0xff00ff00
    s_mov_b32 s51, 0xff00ff00
    s_mov_b64 s[94:95], -1
    s_mov_b32 s59, 0
    s_lshr_b32 s53, s30, 1
    s_lshl_b32 s53, s53, 11
    s_lshl_b32 s54, s29, 8
    s_add_u32 s53, s53, s54
    s_and_b32 s54, s30, 1
    s_lshl_b32 s54, s54, 7
    s_add_u32 s53, s53, s54
    s_and_b32 s54, s28, 1
    s_lshl_b32 s54, s54, 6
    s_add_u32 s80, s53, s54
    v_lshlrev_b32 v224, 2, v2
    v_lshlrev_b32 v227, 3, v2
    buffer_load_dword v16, v224, s[40:43], s80 offen
    s_waitcnt vmcnt(10)
    v_lshlrev_b32 v64, 16, v32
    v_and_b32 v65, 0xffff0000, v32
    v_lshlrev_b32 v66, 16, v33
    v_and_b32 v67, 0xffff0000, v33
    v_lshlrev_b32 v68, 16, v34
    v_and_b32 v69, 0xffff0000, v34
    v_lshlrev_b32 v70, 16, v35
    v_and_b32 v71, 0xffff0000, v35
    v_lshlrev_b32 v72, 16, v36
    v_and_b32 v73, 0xffff0000, v36
    v_lshlrev_b32 v74, 16, v37
    v_and_b32 v75, 0xffff0000, v37
    v_lshlrev_b32 v76, 16, v38
    v_and_b32 v77, 0xffff0000, v38
    v_lshlrev_b32 v78, 16, v39
    v_and_b32 v79, 0xffff0000, v39
    v_add_f32 v31, v64, v65
    v_add_f32 v9, v66, v67
    v_add_f32 v31, v31, v68
    v_add_f32 v9, v9, v69
    v_add_f32 v31, v31, v70
    v_add_f32 v9, v9, v71
    v_add_f32 v31, v31, v72
    v_add_f32 v9, v9, v73
    v_add_f32 v31, v31, v74
    v_add_f32 v9, v9, v75
    v_add_f32 v31, v31, v76
    v_add_f32 v9, v9, v77
    v_add_f32 v31, v31, v78
    v_add_f32 v9, v9, v79
    v_add_f32 v31, v31, v9
    s_nop 1
    v_add_f32_dpp v31, v31, v31 row_ror:8 row_mask:0xf bank_mask:0xf
    s_nop 1
    v_add_f32_dpp v31, v31, v31 row_ror:4 row_mask:0xf bank_mask:0xf
    s_nop 1
    v_add_f32_dpp v31, v31, v31 row_ror:2 row_mask:0xf bank_mask:0xf
    s_nop 1
    v_add_f32_dpp v31, v31, v31 row_ror:1 row_mask:0xf bank_mask:0xf
    v_mov_b32 v9, v31
    s_nop 1
    v_permlane16_swap_b32 v31, v9
    s_nop 0
    v_add_f32 v31, v31, v9
    v_mov_b32 v9, v31
    s_nop 1
    v_permlane32_swap_b32 v31, v9
    s_nop 0
    v_add_f32 v31, v31, v9
    v_mul_f32 v28, 0x3a800000, v31
    v_sub_f32 v9, v64, v28
    v_mul_f32 v31, v9, v9
    v_sub_f32 v9, v65, v28
    v_fmac_f32 v31, v9, v9
    v_sub_f32 v9, v66, v28
    v_fmac_f32 v31, v9, v9
    v_sub_f32 v9, v67, v28
    v_fmac_f32 v31, v9, v9
    v_sub_f32 v9, v68, v28
    v_fmac_f32 v31, v9, v9
    v_sub_f32 v9, v69, v28
    v_fmac_f32 v31, v9, v9
    v_sub_f32 v9, v70, v28
    v_fmac_f32 v31, v9, v9
    v_sub_f32 v9, v71, v28
    v_fmac_f32 v31, v9, v9
    v_sub_f32 v9, v72, v28
    v_fmac_f32 v31, v9, v9
    v_sub_f32 v9, v73, v28
    v_fmac_f32 v31, v9, v9
    v_sub_f32 v9, v74, v28
    v_fmac_f32 v31, v9, v9
    v_sub_f32 v9, v75, v28
    v_fmac_f32 v31, v9, v9
    v_sub_f32 v9, v76, v28
    v_fmac_f32 v31, v9, v9
    v_sub_f32 v9, v77, v28
    v_fmac_f32 v31, v9, v9
    v_sub_f32 v9, v78, v28
    v_fmac_f32 v31, v9, v9
    v_sub_f32 v9, v79, v28
    v_fmac_f32 v31, v9, v9
    s_nop 1
    v_add_f32_dpp v31, v31, v31 row_ror:8 row_mask:0xf bank_mask:0xf
    s_nop 1
    v_add_f32_dpp v31, v31, v31 row_ror:4 row_mask:0xf bank_mask:0xf
    s_nop 1
    v_add_f32_dpp v31, v31, v31 row_ror:2 row_mask:0xf bank_mask:0xf
    s_nop 1
    v_add_f32_dpp v31, v31, v31 row_ror:1 row_mask:0xf bank_mask:0xf
    v_mov_b32 v9, v31
    s_nop 1
    v_permlane16_swap_b32 v31, v9
    s_nop 0
    v_add_f32 v31, v31, v9
    v_mov_b32 v9, v31
    s_nop 1
    v_permlane32_swap_b32 v31, v9
    s_nop 0
    v_add_f32 v31, v31, v9
    v_mul_f32 v30, 0x3a800000, v31
    v_cvt_pk_bf16_f32 v30, v30, v30
    v_lshlrev_b32 v30, 16, v30
    v_add_f32 v30, 0x3727c5ac, v30
    v_cvt_pk_bf16_f32 v30, v30, v30
    v_lshlrev_b32 v30, 16, v30
    v_sqrt_f32 v30, v30
    v_cvt_pk_bf16_f32 v28, v28, v28
    v_lshlrev_b32 v28, 16, v28
    v_cvt_pk_bf16_f32 v30, v30, v30
    v_lshlrev_b32 v30, 16, v30
    v_rcp_f32 v29, v30
    s_nop 0
    v_lshlrev_b32 v64, 16, v40
    v_and_b32 v65, 0xffff0000, v40
    v_lshlrev_b32 v66, 16, v41
    v_and_b32 v67, 0xffff0000, v41
    v_lshlrev_b32 v68, 16, v42
    v_and_b32 v69, 0xffff0000, v42
    v_lshlrev_b32 v70, 16, v43
    v_and_b32 v71, 0xffff0000, v43
    v_sub_f32 v64, v64, v28
    v_sub_f32 v65, v65, v28
    v_cvt_pk_bf16_f32 v9, v64, v65
    v_lshlrev_b32 v64, 16, v9
    v_and_b32 v65, 0xffff0000, v9
    v_mul_f32 v9, v64, v29
    v_mul_f32 v10, v65, v29
    v_fma_f32 v64, -v9, v30, v64
    v_fma_f32 v65, -v10, v30, v65
    v_fmac_f32 v9, v64, v29
    v_fmac_f32 v10, v65, v29
    v_cvt_pk_bf16_f32 v48, v9, v10
    v_sub_f32 v66, v66, v28
    v_sub_f32 v67, v67, v28
    v_cvt_pk_bf16_f32 v9, v66, v67
    v_lshlrev_b32 v66, 16, v9
    v_and_b32 v67, 0xffff0000, v9
    v_mul_f32 v9, v66, v29
    v_mul_f32 v10, v67, v29
    v_fma_f32 v66, -v9, v30, v66
    v_fma_f32 v67, -v10, v30, v67
    v_fmac_f32 v9, v66, v29
    v_fmac_f32 v10, v67, v29
    v_cvt_pk_bf16_f32 v49, v9, v10
    v_sub_f32 v68, v68, v28
    v_sub_f32 v69, v69, v28
    v_cvt_pk_bf16_f32 v9, v68, v69
    v_lshlrev_b32 v68, 16, v9
    v_and_b32 v69, 0xffff0000, v9
    v_mul_f32 v9, v68, v29
    v_mul_f32 v10, v69, v29
    v_fma_f32 v68, -v9, v30, v68
    v_fma_f32 v69, -v10, v30, v69
    v_fmac_f32 v9, v68, v29
    v_fmac_f32 v10, v69, v29
    v_cvt_pk_bf16_f32 v50, v9, v10
    v_sub_f32 v70, v70, v28
    v_sub_f32 v71, v71, v28
    v_cvt_pk_bf16_f32 v9, v70, v71
    v_lshlrev_b32 v70, 16, v9
    v_and_b32 v71, 0xffff0000, v9
    v_mul_f32 v9, v70, v29
    v_mul_f32 v10, v71, v29
    v_fma_f32 v70, -v9, v30, v70
    v_fma_f32 v71, -v10, v30, v71
    v_fmac_f32 v9, v70, v29
    v_fmac_f32 v10, v71, v29
    v_cvt_pk_bf16_f32 v51, v9, v10
    v_and_b32 v11, 7, v1
    v_lshlrev_b32 v226, 2, v11
    v_and_b32 v9, 3, v11
    v_lshlrev_b32 v9, 1, v9
    v_bfe_u32 v10, v11, 2, 1
    v_or_b32 v9, v9, v10
    v_xor_b32 v9, s28, v9
    v_lshlrev_b32 v9, 4, v9
    v_lshl_add_u32 v9, v1, 7, v9
    v_add_u32 v9, 131072, v9
    s_mov_b64 exec, 0xffffffff
    ds_write_b128 v9, v[48:51]
    s_mov_b64 exec, -1
    s_mov_b32 s40, s24
    s_and_b32 s41, s25, 0xffff
    s_mov_b32 s42, 0x100
    s_mov_b32 s43, 0x20000
    s_getreg_b32 s97, hwreg(HW_REG_XCC_ID, 0, 4)
    s_add_u32 s97, s97, 1
    s_lshl_b32 s98, s29, 5
    s_cmp_lg_u32 s28, 4
    s_cbranch_scc1 L_noxcc_1
    s_lshr_b32 s54, s2, 3
    s_add_u32 s53, s98, s54
    v_mov_b32 v9, s97
    s_mov_b64 exec, 1
    buffer_store_byte v9, v19, s[40:43], s53 offen sc1
    s_mov_b64 exec, -1
L_noxcc_1:
    s_mul_i32 s97, s97, 0x01010101
    v_bfe_u32 v9, v1, 2, 2
    v_and_b32 v6, 1, v3
    v_lshl_or_b32 v6, v6, 2, v9
    v_xor_b32 v6, s28, v6
    v_lshlrev_b32 v6, 5, v6
    v_lshl_add_u32 v9, v3, 3, v9
    v_lshl_add_u32 v6, v9, 8, v6
    v_and_b32 v9, 3, v1
    v_lshl_add_u32 v6, v9, 3, v6
    v_and_b32 v9, 7, v1
    v_lshlrev_b32 v7, 1, v3
    v_xor_b32 v7, v7, v9
    v_lshlrev_b32 v7, 4, v7
    v_lshl_add_u32 v7, v3, 7, v7
    v_add_u32 v7, 131072, v7
    v_xor_b32 v8, 16, v7
    v_and_b32 v9, 7, v1
    v_lshlrev_b32 v13, 10, v9
    v_lshrrev_b32 v9, 3, v2
    v_lshl_add_u32 v9, v3, 1, v9
    v_lshl_add_u32 v13, v9, 4, v13
    s_lshl_b32 s53, s28, 7
    v_add_u32 v13, s53, v13
    s_lshl_b32 s53, s55, 2
    s_add_u32 s53, s53, s56
    s_lshl_b32 s53, s53, 13
    s_add_u32 s81, s53, 0x100000
    s_waitcnt lgkmcnt(0)
    s_mov_b64 s[94:95], 0
    s_mov_b64 s[62:63], 0
    s_mov_b64 s[92:93], 0
    s_mov_b32 s59, 1
    s_mov_b32 s3, 8
    s_mov_b64 exec, s[94:95]
L_q_top:
    ds_read_b64_tr_b16 v[96:97], v6 offset:0
    ds_read_b64_tr_b16 v[98:99], v6 offset:1024
    ds_read_b64_tr_b16 v[100:101], v6 offset:8192
    ds_read_b64_tr_b16 v[102:103], v6 offset:9216
    ds_read_b64_tr_b16 v[104:105], v6 offset:16384
    ds_read_b64_tr_b16 v[106:107], v6 offset:17408
    ds_read_b64_tr_b16 v[108:109], v6 offset:24576
    ds_read_b64_tr_b16 v[110:111], v6 offset:25600
    ds_read_b64_tr_b16 v[112:113], v6 offset:32768
    ds_read_b64_tr_b16 v[114:115], v6 offset:33792
    ds_read_b64_tr_b16 v[116:117], v6 offset:40960
    ds_read_b64_tr_b16 v[118:119], v6 offset:41984
    ds_read_b64_tr_b16 v[120:121], v6 offset:49152
    ds_read_b64_tr_b16 v[122:123], v6 offset:50176
    ds_read_b64_tr_b16 v[124:125], v6 offset:57344
    ds_read_b64_tr_b16 v[126:127], v6 offset:58368
    ds_read_b128 v[128:131], v7 offset:0
    ds_read_b128 v[132:135], v8 offset:512
    ds_read_b128 v[136:139], v7 offset:1024
    ds_read_b128 v[140:143], v8 offset:1536
    ds_read_b128 v[144:147], v7 offset:2048
    ds_read_b128 v[148:151], v8 offset:2560
    ds_read_b128 v[152:155], v7 offset:3072
    ds_read_b128 v[156:159], v8 offset:3584
    s_waitcnt lgkmcnt(7)
    v_mfma_f32_16x16x32_bf16 v[20:23], v[96:99], v[128:131], 0
    s_waitcnt lgkmcnt(6)
    v_mfma_f32_16x16x32_bf16 v[20:23], v[100:103], v[132:135], v[20:23]
    s_waitcnt lgkmcnt(5)
    v_mfma_f32_16x16x32_bf16 v[20:23], v[104:107], v[136:139], v[20:23]
    s_waitcnt lgkmcnt(4)
    v_mfma_f32_16x16x32_bf16 v[20:23], v[108:111], v[140:143], v[20:23]
    s_waitcnt lgkmcnt(3)
    v_mfma_f32_16x16x32_bf16 v[20:23], v[112:115], v[144:147], v[20:23]
    s_waitcnt lgkmcnt(2)
    v_mfma_f32_16x16x32_bf16 v[20:23], v[116:119], v[148:151], v[20:23]
    s_waitcnt lgkmcnt(1)
    v_mfma_f32_16x16x32_bf16 v[20:23], v[120:123], v[152:155], v[20:23]
    s_waitcnt lgkmcnt(0)
    v_mfma_f32_16x16x32_bf16 v[20:23], v[124:127], v[156:159], v[20:23]
    s_nop 7
    v_cndmask_b32 v24, v20, v22, s[50:51]
    v_cndmask_b32 v25, v21, v23, s[50:51]
    s_cbranch_execz L_ns_2
    buffer_store_dwordx4 v[24:27], v13, s[36:39], s81 offen sc1
L_ns_2:
    s_cmp_eq_u32 s59, 0
    s_cbranch_scc1 L_q_done
L_q_real:
    s_mov_b64 s[94:95], -1
    s_mov_b32 s59, 0
    s_mov_b32 s3, 2
    s_mov_b64 exec, s[94:95]
    s_waitcnt vmcnt(1)
    v_readfirstlane_b32 s58, v44
    s_nop 3
    s_mul_i32 s31, s58, 0x9e3779b1
    s_add_u32 s31, s31, 0x85ebca6b
    s_mov_b32 s48, s31
    s_mov_b32 s49, s31
    s_add_u32 s58, s58, 1
    v_mov_b32 v26, s31
    v_mov_b32 v27, s31
    s_waitcnt vmcnt(0) lgkmcnt(0)
    s_barrier
    s_branch L_q_top
L_q_done:
    v_bfe_u32 v9, v1, 1, 3
    v_xor_b32 v9, v3, v9
    v_lshlrev_b32 v9, 5, v9
    v_and_b32 v4, 1, v1
    v_lshl_add_u32 v9, v4, 4, v9
    v_mul_u32_u24 v4, 2048, v3
    v_add_u32 v4, v4, v9
    v_xor_b32 v5, 0x80, v4
    v_add_u32 v229, 65536, v6
    s_and_b32 s53, s28, 1
    s_lshl_b32 s53, s53, 7
    v_xor_b32 v238, s53, v4
    v_xor_b32 v239, 0x80, v238
    v_bfe_u32 v11, v1, 1, 3
    v_and_b32 v9, 3, v11
    v_lshlrev_b32 v9, 1, v9
    v_bfe_u32 v10, v11, 2, 1
    v_or_b32 v9, v9, v10
    v_xor_b32 v9, s28, v9
    v_lshlrev_b32 v9, 4, v9
    v_lshrrev_b32 v10, 1, v1
    v_lshl_add_u32 v9, v10, 7, v9
    v_and_b32 v10, 1, v1
    v_lshl_add_u32 v9, v10, 3, v9
    v_add_u32 v17, 131072, v9
    v_lshlrev_b32 v14, 13, v3
    v_lshl_add_u32 v14, v2, 4, v14
    s_and_b32 s53, s28, 1
    s_lshl_b32 s53, s53, 8
    v_add_u32 v14, s53, v14
    s_lshl_b32 s53, s30, 3
    s_or_b32 s53, s53, s29
    s_lshl_b32 s53, s53, 7
    s_add_u32 s83, s53, 0x4000
    s_lshl_b32 s53, s30, 3
    s_add_u32 s53, s53, s28
    s_lshl_b32 s53, s53, 10
    s_add_u32 s82, s53, 0x2e0000
    s_lshl_b32 s53, s29, 4
    s_add_u32 s53, s53, s30
    s_lshl_b32 s53, s53, 13
    s_add_u32 s84, s53, 0x300000
    s_lshl_b32 s53, s29, 17
    s_lshl_b32 s54, s30, 9
    s_add_u32 s53, s53, s54
    s_add_u32 s85, s53, 0x300000
    s_add_u32 s86, s53, 0x400000
    s_add_u32 s4, s85, 0
    s_add_u32 s8, s86, 0
    s_add_u32 s5, s85, 32768
    s_add_u32 s9, s86, 32768
    s_add_u32 s6, s85, 65536
    s_add_u32 s10, s86, 65536
    s_add_u32 s7, s85, 98304
    s_add_u32 s11, s86, 98304
    s_lshl_b32 s53, s80, 1
    s_add_u32 s90, s53, 0x280000
    s_lshr_b32 s55, s30, 3
    s_lshl_b32 s53, s29, 1
    s_add_u32 s55, s55, s53
    s_and_b32 s56, s30, 7
    s_mul_i32 s91, s55, 458752
    s_lshl_b32 s53, s56, 8
    s_add_u32 s91, s91, s53
    s_min_u32 s53, s28, 6
    s_lshl_b32 s54, s53, 10
    s_mul_i32 s57, s55, 7168
    s_add_u32 s57, s57, s54
    s_add_u32 s87, s57, 0x290000
    s_add_u32 s88, s57, 0x2b0000
    s_lshl_b32 s54, s53, 2
    v_add_u32 v12, s54, v3
    v_and_b32 v11, 7, v12
    v_and_b32 v9, 3, v11
    v_lshlrev_b32 v9, 1, v9
    v_bfe_u32 v10, v11, 2, 1
    v_or_b32 v9, v9, v10
    v_and_b32 v10, 7, v1
    v_xor_b32 v9, v9, v10
    v_lshlrev_b32 v9, 4, v9
    v_lshl_add_u32 v9, v12, 7, v9
    v_bfe_u32 v10, v1, 3, 1
    v_lshl_add_u32 v9, v10, 3, v9
    v_add_u32 v225, 131072, v9
    s_lshl_b32 s53, s56, 4
    s_add_u32 s53, s53, s55
    s_lshl_b32 s53, s53, 13
    s_add_u32 s89, s53, 0x400000
    v_and_b32 v9, 31, v1
    v_lshlrev_b32 v9, 4, v9
    v_add_u32 v228, 134656, v9
    v_mov_b32 v232, 0
    v_mov_b32 v233, 0
    v_mov_b32 v234, 0
    v_mov_b32 v235, 0
    s_mov_b32 s44, s22
    s_and_b32 s45, s23, 0xffff
    s_mov_b32 s46, 0x4000
    s_mov_b32 s47, 0x20000
    s_lshr_b32 s57, s16, 7
    s_mul_i32 s53, s29, 7
    s_add_u32 s57, s57, s53
    s_sub_u32 s57, 3, s57
    s_and_b32 s57, s57, 7
    s_lshr_b32 s53, s30, 3
    s_mul_i32 s53, s53, 56
    s_min_u32 s54, s28, 6
    s_lshl_b32 s54, s54, 3
    s_add_u32 s53, s53, s54
    s_lshr_b32 s54, s53, 4
    s_cmp_eq_u32 s54, s57
    s_cselect_b32 s96, 1, 0
    s_and_b32 s53, s53, 8
    s_lshl_b32 s53, s53, 8
    s_lshl_b32 s54, s29, 12
    s_add_u32 s53, s53, s54
    s_add_u32 s81, s53, 0x500000
    v_lshlrev_b32 v230, 5, v1
    v_add_u32 v231, 0x8000, v230
    v_add_u32 v236, 0x10000, v230
    v_add_u32 v237, 0x18000, v230
    s_lshl_b32 s99, s30, 19
    s_lshl_b32 s53, s29, 8
    s_add_u32 s99, s99, s53
    s_barrier
    s_cmp_ge_u32 s28, 4
    s_cbranch_scc1 L_b_warm
    s_mov_b32 s32, s12
    s_and_b32 s33, s13, 0xffff
    s_mov_b32 s34, 0x800000
    s_mov_b32 s35, 0x20000
L_poll_3:
    s_cbranch_execz L_poll_3_nl
    buffer_load_dwordx2 v[32:33], v19, s[36:39], s83 offen sc1
    buffer_load_dword v34, v226, s[40:43], s98 offen sc1
    s_waitcnt vmcnt(0)
L_poll_3_nl:
    v_cmpx_eq_u64 vcc, s[48:49], v[32:33]
    v_subrev_u32 v9, 0x01010101, v34
    v_bfi_b32 v9, v34, 0, v9
    v_and_b32 v9, 0x80808080, v9
    v_cmpx_eq_u32 vcc, 0, v9
    s_cmp_eq_u64 exec, s[94:95]
    s_mov_b64 exec, s[94:95]
    s_cbranch_scc1 L_poll_3_ok
    s_sub_u32 s52, s52, 1
    s_cbranch_scc0 L_poll_3
    s_mov_b32 s52, 0
L_poll_3_ok:
    v_cmp_ne_u32 vcc, s97, v34
    s_nop 1
    s_cmp_eq_u64 vcc, 0
    s_cselect_b64 s[62:63], s[94:95], 0
    s_cselect_b64 s[92:93], 0, s[94:95]
    s_mul_i32 s53, s28, 131072
    s_add_u32 s53, s53, s99
    s_mul_i32 s54, s28, 16384
    s_add_u32 s54, s54, 65536
    s_mov_b32 m0, s54
    s_add_u32 s54, s54, 1024
    buffer_load_dwordx4 v4, s[32:35], s53 offen nt lds
    s_add_u32 s53, s53, 8192
    s_mov_b32 m0, s54
    s_add_u32 s54, s54, 1024
    buffer_load_dwordx4 v4, s[32:35], s53 offen nt lds
    s_add_u32 s53, s53, 8192
    s_mov_b32 m0, s54
    s_add_u32 s54, s54, 1024
    buffer_load_dwordx4 v5, s[32:35], s53 offen nt lds
    s_add_u32 s53, s53, 8192
    s_mov_b32 m0, s54
    s_add_u32 s54, s54, 1024
    buffer_load_dwordx4 v5, s[32:35], s53 offen nt lds
    s_add_u32 s53, s53, 8192
    s_mov_b32 m0, s54
    s_add_u32 s54, s54, 1024
    buffer_load_dwordx4 v4, s[32:35], s53 offen nt lds
    s_add_u32 s53, s53, 8192
    s_mov_b32 m0, s54
    s_add_u32 s54, s54, 1024
    buffer_load_dwordx4 v4, s[32:35], s53 offen nt lds
    s_add_u32 s53, s53, 8192
    s_mov_b32 m0, s54
    s_add_u32 s54, s54, 1024
    buffer_load_dwordx4 v5, s[32:35], s53 offen nt lds
    s_add_u32 s53, s53, 8192
    s_mov_b32 m0, s54
    s_add_u32 s54, s54, 1024
    buffer_load_dwordx4 v5, s[32:35], s53 offen nt lds
    s_add_u32 s53, s53, 8192
    s_mov_b32 m0, s54
    s_add_u32 s54, s54, 1024
    buffer_load_dwordx4 v4, s[32:35], s53 offen nt lds
    s_add_u32 s53, s53, 8192
    s_mov_b32 m0, s54
    s_add_u32 s54, s54, 1024
    buffer_load_dwordx4 v4, s[32:35], s53 offen nt lds
    s_add_u32 s53, s53, 8192
    s_mov_b32 m0, s54
    s_add_u32 s54, s54, 1024
    buffer_load_dwordx4 v5, s[32:35], s53 offen nt lds
    s_add_u32 s53, s53, 8192
    s_mov_b32 m0, s54
    s_add_u32 s54, s54, 1024
    buffer_load_dwordx4 v5, s[32:35], s53 offen nt lds
    s_add_u32 s53, s53, 8192
    s_mov_b32 m0, s54
    s_add_u32 s54, s54, 1024
    buffer_load_dwordx4 v4, s[32:35], s53 offen nt lds
    s_add_u32 s53, s53, 8192
    s_mov_b32 m0, s54
    s_add_u32 s54, s54, 1024
    buffer_load_dwordx4 v4, s[32:35], s53 offen nt lds
    s_add_u32 s53, s53, 8192
    s_mov_b32 m0, s54
    s_add_u32 s54, s54, 1024
    buffer_load_dwordx4 v5, s[32:35], s53 offen nt lds
    s_add_u32 s53, s53, 8192
    s_mov_b32 m0, s54
    s_nop 0
    buffer_load_dwordx4 v5, s[32:35], s53 offen nt lds
    s_waitcnt vmcnt(0)
    s_branch L_b_real
L_b_warm:
    s_cmp_lg_u32 s28, 4
    s_cbranch_scc1 L_b_notouch
    v_lshlrev_b32 v9, 7, v1
    v_lshrrev_b32 v10, 2, v1
    v_lshlrev_b32 v10, 13, v10
    v_and_b32 v11, 3, v1
    v_lshl_add_u32 v10, v11, 7, v10
    s_sub_u32 s53, s87, 4096
    s_sub_u32 s54, s88, 4096
    s_lshl_b32 s55, s29, 12
    s_add_u32 s55, s55, 0x500000
    v_and_b32 v11, 31, v1
    v_lshlrev_b32 v11, 7, v11
    v_lshrrev_b32 v12, 5, v1
    v_lshl_add_u32 v11, v12, 15, v11
    v_add_u32 v12, 0x10000, v11
    buffer_load_dword v244, v10, s[36:39], s85 offen offset:0 sc1
    buffer_load_dword v245, v9, s[36:39], s53 offen offset:0 sc1
    buffer_load_dword v246, v9, s[36:39], s54 offen offset:0 sc1
    buffer_load_dword v247, v11, s[36:39], s55 offen offset:0 sc1
    buffer_load_dword v248, v12, s[36:39], s55 offen offset:0 sc1
    buffer_load_dword v249, v19, s[36:39], s82 offen offset:0 sc1
    buffer_load_dword v250, v19, s[36:39], s86 offen offset:0 sc1
    buffer_load_dword v251, v19, s[36:39], s89 offen offset:0 sc1
    buffer_load_dword v252, v19, s[36:39], s90 offen offset:0 sc1
    v_mov_b32 v9, s99
    v_mov_b32 v10, s91
    global_load_dword v253, v9, s[12:13]
    global_load_dword v254, v10, s[20:21]
    global_load_dword v255, v19, s[22:23]
L_b_notouch:
    s_mov_b64 s[94:95], 0
    s_mov_b64 s[62:63], 0
    s_mov_b64 s[92:93], 0
    s_mov_b32 s59, 1
    s_mov_b32 s3, 8
    s_mov_b64 exec, s[94:95]
    s_branch L_b_tail
L_b_real0:
    s_mov_b64 s[94:95], -1
    s_mov_b32 s59, 0
    s_mov_b32 s3, 2
    s_mov_b64 exec, s[94:95]
L_poll_4:
    s_cbranch_execz L_poll_4_nl
    buffer_load_dword v32, v226, s[40:43], s98 offen sc1
    s_waitcnt vmcnt(0)
L_poll_4_nl:
    v_subrev_u32 v9, 0x01010101, v32
    v_bfi_b32 v9, v32, 0, v9
    v_and_b32 v9, 0x80808080, v9
    v_cmpx_eq_u32 vcc, 0, v9
    s_cmp_eq_u64 exec, s[94:95]
    s_mov_b64 exec, s[94:95]
    s_cbranch_scc1 L_poll_4_ok
    s_sub_u32 s52, s52, 1
    s_cbranch_scc0 L_poll_4
    s_mov_b32 s52, 0
L_poll_4_ok:
    v_cmp_ne_u32 vcc, s97, v32
    s_nop 1
    s_cmp_eq_u64 vcc, 0
    s_cselect_b64 s[62:63], s[94:95], 0
    s_cselect_b64 s[92:93], 0, s[94:95]
L_b_real:
    s_barrier
L_b_tail:
    ds_read_b64_tr_b16 v[96:97], v229 offset:0
    ds_read_b64_tr_b16 v[98:99], v229 offset:1024
    ds_read_b64_tr_b16 v[100:101], v229 offset:8192
    ds_read_b64_tr_b16 v[102:103], v229 offset:9216
    ds_read_b64_tr_b16 v[104:105], v229 offset:16384
    ds_read_b64_tr_b16 v[106:107], v229 offset:17408
    ds_read_b64_tr_b16 v[108:109], v229 offset:24576
    ds_read_b64_tr_b16 v[110:111], v229 offset:25600
    ds_read_b64_tr_b16 v[112:113], v229 offset:32768
    ds_read_b64_tr_b16 v[114:115], v229 offset:33792
    ds_read_b64_tr_b16 v[116:117], v229 offset:40960
    ds_read_b64_tr_b16 v[118:119], v229 offset:41984
    ds_read_b64_tr_b16 v[120:121], v229 offset:49152
    ds_read_b64_tr_b16 v[122:123], v229 offset:50176
    ds_read_b64_tr_b16 v[124:125], v229 offset:57344
    ds_read_b64_tr_b16 v[126:127], v229 offset:58368
    s_cbranch_execz L_bell_5_ok
L_bell_5:
    s_mov_b64 exec, 1
    buffer_load_dword v9, v18, s[36:39], s82 offen offset:12 sc1
    s_waitcnt vmcnt(0)
    v_cmpx_eq_u32 vcc, s31, v9
    s_cbranch_execnz L_bell_5_ok
    s_sleep 1
    s_sub_u32 s52, s52, 1
    s_cbranch_scc0 L_bell_5
    s_mov_b32 s52, 0
L_bell_5_ok:
    s_mov_b64 exec, s[94:95]
L_poll_6:
    s_cbranch_execz L_poll_6_nl
    buffer_load_dwordx4 v[32:35], v18, s[36:39], s82 offen sc1
    s_waitcnt vmcnt(0)
L_poll_6_nl:
    v_cmpx_eq_u64 vcc, s[48:49], v[34:35]
    s_cmp_eq_u64 exec, s[94:95]
    s_mov_b64 exec, s[94:95]
    s_cbranch_scc1 L_poll_6_ok
    s_sub_u32 s52, s52, 1
    s_cbranch_scc0 L_poll_6
    s_mov_b32 s52, 0
L_poll_6_ok:
    ds_write_b64 v17, v[32:33]
    s_waitcnt lgkmcnt(0)
    s_cbranch_execz L_nb_7
    s_barrier
L_nb_7:
    ds_read_b128 v[128:131], v7 offset:0
    ds_read_b128 v[132:135], v8 offset:512
    ds_read_b128 v[136:139], v7 offset:1024
    ds_read_b128 v[140:143], v8 offset:1536
    ds_read_b128 v[144:147], v7 offset:2048
    ds_read_b128 v[148:151], v8 offset:2560
    ds_read_b128 v[152:155], v7 offset:3072
    ds_read_b128 v[156:159], v8 offset:3584
    s_waitcnt lgkmcnt(7)
    v_mfma_f32_16x16x32_bf16 v[20:23], v[96:99], v[128:131], 0
    s_waitcnt lgkmcnt(6)
    v_mfma_f32_16x16x32_bf16 v[20:23], v[100:103], v[132:135], v[20:23]
    s_waitcnt lgkmcnt(5)
    v_mfma_f32_16x16x32_bf16 v[20:23], v[104:107], v[136:139], v[20:23]
    s_waitcnt lgkmcnt(4)
    v_mfma_f32_16x16x32_bf16 v[20:23], v[108:111], v[140:143], v[20:23]
    s_waitcnt lgkmcnt(3)
    v_mfma_f32_16x16x32_bf16 v[20:23], v[112:115], v[144:147], v[20:23]
    s_waitcnt lgkmcnt(2)
    v_mfma_f32_16x16x32_bf16 v[20:23], v[116:119], v[148:151], v[20:23]
    s_waitcnt lgkmcnt(1)
    v_mfma_f32_16x16x32_bf16 v[20:23], v[120:123], v[152:155], v[20:23]
    s_waitcnt lgkmcnt(0)
    v_mfma_f32_16x16x32_bf16 v[20:23], v[124:127], v[156:159], v[20:23]
    s_nop 7
    v_cndmask_b32 v24, v20, v22, s[50:51]
    v_cndmask_b32 v25, v21, v23, s[50:51]
    s_mov_b64 exec, s[62:63]
    s_cbranch_execz L_ns_8
    buffer_store_dwordx4 v[24:27], v13, s[36:39], s84 offen
L_ns_8:
    s_mov_b64 exec, s[92:93]
    s_cbranch_execz L_ns_9
    buffer_store_dwordx4 v[24:27], v13, s[36:39], s84 offen sc1
L_ns_9:
    s_mov_b64 exec, s[94:95]
    s_cmp_ge_u32 s28, s3
    s_cbranch_scc1 L_b_nor3
L_poll_10:
    s_cbranch_execz L_poll_10_nl
    buffer_load_dwordx4 v[32:35], v14, s[36:39], s4 offen sc1
    buffer_load_dwordx4 v[36:39], v14, s[36:39], s5 offen sc1
    buffer_load_dwordx4 v[40:43], v14, s[36:39], s6 offen sc1
    buffer_load_dwordx4 v[44:47], v14, s[36:39], s7 offen sc1
    s_waitcnt vmcnt(0)
L_poll_10_nl:
    v_cmpx_eq_u64 vcc, s[48:49], v[34:35]
    v_cmpx_eq_u64 vcc, s[48:49], v[38:39]
    v_cmpx_eq_u64 vcc, s[48:49], v[42:43]
    v_cmpx_eq_u64 vcc, s[48:49], v[46:47]
    s_cmp_eq_u64 exec, s[94:95]
    s_mov_b64 exec, s[94:95]
    s_cbranch_scc1 L_poll_10_ok
    s_sub_u32 s52, s52, 1
    s_cbranch_scc0 L_poll_10
    s_mov_b32 s52, 0
L_poll_10_ok:
    v_pk_add_f32 v[32:33], v[32:33], v[36:37]
    v_pk_add_f32 v[40:41], v[40:41], v[44:45]
    v_pk_add_f32 v[32:33], v[32:33], v[40:41]
    s_nop 1
    v_permlane32_swap_b32 v32, v33
    s_nop 0
    v_add_f32 v32, v32, v33
    v_mov_b32 v33, v32
    s_nop 1
    v_permlane16_swap_b32 v32, v33
    s_nop 0
    v_add_f32 v32, v32, v33
    v_mov_b32 v33, v32
    s_nop 1
    v_permlane32_swap_b32 v32, v33
    s_nop 0
    v_cvt_pk_bf16_f32 v9, v32, v33
    v_lshlrev_b32 v66, 16, v16
    v_and_b32 v67, 0xffff0000, v16
    v_lshlrev_b32 v64, 16, v9
    v_and_b32 v65, 0xffff0000, v9
    v_add_f32 v64, v64, v66
    v_add_f32 v65, v65, v67
    v_cvt_pk_bf16_f32 v68, v64, v65
    v_mov_b32 v70, s31
    v_mov_b32 v71, s31
    v_mov_b32_dpp v69, v68 quad_perm:[1,1,3,3] row_mask:0xf bank_mask:0xf
    s_and_b64 exec, s[94:95], 0x5555
    s_cbranch_execz L_ns_11
    buffer_store_dwordx4 v[68:71], v227, s[36:39], s90 offen sc1
L_ns_11:
    s_mov_b64 exec, s[94:95]
    v_mov_b32 v15, v68
L_b_nor3:
    s_cbranch_execz L_nb_12
    s_barrier
L_nb_12:
    s_mov_b32 s32, s20
    s_and_b32 s33, s21, 0xffff
    s_mov_b32 s34, 0x700000
    s_mov_b32 s35, 0x20000
    s_cbranch_execz L_bell_13_ok
L_bell_13:
    s_mov_b64 exec, 1
    buffer_load_dword v9, v19, s[36:39], s83 offen offset:8 sc1
    s_waitcnt vmcnt(0)
    v_cmpx_eq_u32 vcc, s31, v9
    s_cbranch_execnz L_bell_13_ok
    s_sleep 1
    s_sub_u32 s52, s52, 1
    s_cbranch_scc0 L_bell_13
    s_mov_b32 s52, 0
L_bell_13_ok:
    s_mov_b64 exec, s[94:95]
    s_cmp_eq_u32 s28, 7
    s_cbranch_scc1 L_b_nod7
    s_mul_i32 s53, s28, 65536
    s_add_u32 s53, s53, s91
    s_mul_i32 s54, s28, 8192
    s_mov_b32 m0, s54
    s_add_u32 s54, s54, 1024
    s_cbranch_execz L_sk_14
    buffer_load_dwordx4 v4, s[32:35], s53 offen nt lds
L_sk_14:
    s_add_u32 s53, s53, 8192
    s_mov_b32 m0, s54
    s_add_u32 s54, s54, 1024
    s_cbranch_execz L_sk_15
    buffer_load_dwordx4 v4, s[32:35], s53 offen nt lds
L_sk_15:
    s_add_u32 s53, s53, 8192
    s_mov_b32 m0, s54
    s_add_u32 s54, s54, 1024
    s_cbranch_execz L_sk_16
    buffer_load_dwordx4 v5, s[32:35], s53 offen nt lds
L_sk_16:
    s_add_u32 s53, s53, 8192
    s_mov_b32 m0, s54
    s_add_u32 s54, s54, 1024
    s_cbranch_execz L_sk_17
    buffer_load_dwordx4 v5, s[32:35], s53 offen nt lds
L_sk_17:
    s_add_u32 s53, s53, 8192
    s_mov_b32 m0, s54
    s_add_u32 s54, s54, 1024
    s_cbranch_execz L_sk_18
    buffer_load_dwordx4 v4, s[32:35], s53 offen nt lds
L_sk_18:
    s_add_u32 s53, s53, 8192
    s_mov_b32 m0, s54
    s_add_u32 s54, s54, 1024
    s_cbranch_execz L_sk_19
    buffer_load_dwordx4 v4, s[32:35], s53 offen nt lds
L_sk_19:
    s_add_u32 s53, s53, 8192
    s_mov_b32 m0, s54
    s_add_u32 s54, s54, 1024
    s_cbranch_execz L_sk_20
    buffer_load_dwordx4 v5, s[32:35], s53 offen nt lds
L_sk_20:
    s_add_u32 s53, s53, 8192
    s_mov_b32 m0, s54
    s_nop 0
    s_cbranch_execz L_sk_21
    buffer_load_dwordx4 v5, s[32:35], s53 offen nt lds
L_sk_21:
L_b_nod7:
    s_cbranch_execz L_b_nod
    s_waitcnt vmcnt(0)
    s_barrier
L_b_nod:
    ds_write_b128 v228, v[232:235]
    ds_read_b64_tr_b16 v[96:97], v6 offset:0
    ds_read_b64_tr_b16 v[98:99], v6 offset:1024
    ds_read_b64_tr_b16 v[100:101], v6 offset:8192
    ds_read_b64_tr_b16 v[102:103], v6 offset:9216
    ds_read_b64_tr_b16 v[104:105], v6 offset:16384
    ds_read_b64_tr_b16 v[106:107], v6 offset:17408
    ds_read_b64_tr_b16 v[108:109], v6 offset:24576
    ds_read_b64_tr_b16 v[110:111], v6 offset:25600
    ds_read_b64_tr_b16 v[112:113], v6 offset:32768
    ds_read_b64_tr_b16 v[114:115], v6 offset:33792
    ds_read_b64_tr_b16 v[116:117], v6 offset:40960
    ds_read_b64_tr_b16 v[118:119], v6 offset:41984
    ds_read_b64_tr_b16 v[120:121], v6 offset:49152
    ds_read_b64_tr_b16 v[122:123], v6 offset:50176
    ds_read_b64_tr_b16 v[124:125], v6 offset:57344
    ds_read_b64_tr_b16 v[126:127], v6 offset:58368
    s_cmp_eq_u32 s96, 0
    s_cbranch_scc0 L_b_split
L_b_plain:
    s_cbranch_execz L_bell_22_ok
L_bell_22:
    s_mov_b64 exec, 1
    buffer_load_dword v9, v18, s[36:39], s88 offen offset:12 sc1
    s_waitcnt vmcnt(0)
    v_cmpx_eq_u32 vcc, s31, v9
    s_cbranch_execnz L_bell_22_ok
    s_sleep 1
    s_sub_u32 s52, s52, 1
    s_cbranch_scc0 L_bell_22
    s_mov_b32 s52, 0
L_bell_22_ok:
    s_mov_b64 exec, s[94:95]
L_poll_23:
    s_cbranch_execz L_poll_23_nl
    buffer_load_dwordx4 v[32:35], v18, s[36:39], s87 offen sc1
    buffer_load_dwordx4 v[36:39], v18, s[36:39], s88 offen sc1
    s_waitcnt vmcnt(0)
L_poll_23_nl:
    v_cmpx_eq_u32 vcc, s31, v33
    v_cmpx_eq_u32 vcc, s31, v35
    v_cmpx_eq_u32 vcc, s31, v37
    v_cmpx_eq_u32 vcc, s31, v39
    s_cmp_eq_u64 exec, s[94:95]
    s_mov_b64 exec, s[94:95]
    s_cbranch_scc1 L_poll_23_ok
    s_sub_u32 s52, s52, 1
    s_cbranch_scc0 L_poll_23
    s_mov_b32 s52, 0
L_poll_23_ok:
    v_lshlrev_b32 v64, 16, v32
    v_and_b32 v65, 0xffff0000, v32
    v_lshlrev_b32 v68, 16, v36
    v_and_b32 v69, 0xffff0000, v36
    v_lshlrev_b32 v66, 16, v34
    v_and_b32 v67, 0xffff0000, v34
    v_lshlrev_b32 v70, 16, v38
    v_and_b32 v71, 0xffff0000, v38
    s_cbranch_execnz L_b_join
L_b_split:
    s_cbranch_execz L_bell_24_ok
L_bell_24:
    s_mov_b64 exec, 1
    buffer_load_dword v9, v236, s[36:39], s81 offen offset:12 sc1
    s_waitcnt vmcnt(0)
    v_cmpx_eq_u32 vcc, s31, v9
    s_cbranch_execnz L_bell_24_ok
    s_sleep 1
    s_sub_u32 s52, s52, 1
    s_cbranch_scc0 L_bell_24
    s_mov_b32 s52, 0
L_bell_24_ok:
    s_mov_b64 exec, s[94:95]
L_poll_25:
    s_cbranch_execz L_poll_25_nl
    buffer_load_dwordx4 v[32:35], v230, s[36:39], s81 offen offset:0 sc1
    buffer_load_dwordx4 v[36:39], v230, s[36:39], s81 offen offset:16 sc1
    buffer_load_dwordx4 v[40:43], v231, s[36:39], s81 offen offset:0 sc1
    buffer_load_dwordx4 v[44:47], v231, s[36:39], s81 offen offset:16 sc1
L_poll_25_nl:
    s_cbranch_execz L_poll_25x_nl
    buffer_load_dwordx4 v[48:51], v236, s[36:39], s81 offen offset:0 sc1
    buffer_load_dwordx4 v[52:55], v236, s[36:39], s81 offen offset:16 sc1
    buffer_load_dwordx4 v[56:59], v237, s[36:39], s81 offen offset:0 sc1
    buffer_load_dwordx4 v[60:63], v237, s[36:39], s81 offen offset:16 sc1
    s_waitcnt vmcnt(0)
L_poll_25x_nl:
    v_cmpx_eq_u64 vcc, s[48:49], v[34:35]
    v_cmpx_eq_u64 vcc, s[48:49], v[38:39]
    v_cmpx_eq_u64 vcc, s[48:49], v[42:43]
    v_cmpx_eq_u64 vcc, s[48:49], v[46:47]
    v_cmpx_eq_u64 vcc, s[48:49], v[50:51]
    v_cmpx_eq_u64 vcc, s[48:49], v[54:55]
    v_cmpx_eq_u64 vcc, s[48:49], v[58:59]
    v_cmpx_eq_u64 vcc, s[48:49], v[62:63]
    s_cmp_eq_u64 exec, s[94:95]
    s_mov_b64 exec, s[94:95]
    s_cbranch_scc1 L_poll_25_ok
    s_sub_u32 s52, s52, 1
    s_cbranch_scc0 L_poll_25
    s_mov_b32 s52, 0
L_poll_25_ok:
    v_add_f32 v64, v32, v40
    v_add_f32 v65, v33, v41
    v_add_f32 v66, v36, v44
    v_add_f32 v67, v37, v45
    v_add_f32 v68, v48, v56
    v_add_f32 v69, v49, v57
    v_add_f32 v70, v52, v60
    v_add_f32 v71, v53, v61
    v_cvt_pk_bf16_f32 v32, v64, v65
    v_cvt_pk_bf16_f32 v33, v66, v67
    v_cvt_pk_bf16_f32 v34, v68, v69
    v_cvt_pk_bf16_f32 v35, v70, v71
    v_lshlrev_b32 v64, 16, v32
    v_and_b32 v65, 0xffff0000, v32
    v_lshlrev_b32 v66, 16, v33
    v_and_b32 v67, 0xffff0000, v33
    v_lshlrev_b32 v68, 16, v34
    v_and_b32 v69, 0xffff0000, v34
    v_lshlrev_b32 v70, 16, v35
    v_and_b32 v71, 0xffff0000, v35
    v_mul_f32 v64, 0xbfb8aa3b, v64
    v_mul_f32 v65, 0xbfb8aa3b, v65
    v_mul_f32 v66, 0xbfb8aa3b, v66
    v_mul_f32 v67, 0xbfb8aa3b, v67
    v_exp_f32 v64, v64
    v_exp_f32 v65, v65
    v_exp_f32 v66, v66
    v_exp_f32 v67, v67
    v_add_f32 v64, 1.0, v64
    v_add_f32 v65, 1.0, v65
    v_add_f32 v66, 1.0, v66
    v_add_f32 v67, 1.0, v67
    v_rcp_f32 v64, v64
    v_rcp_f32 v65, v65
    v_rcp_f32 v66, v66
    v_rcp_f32 v67, v67
    s_nop 0
    v_cvt_pk_bf16_f32 v32, v64, v65
    v_cvt_pk_bf16_f32 v33, v66, v67
    v_lshlrev_b32 v64, 16, v32
    v_and_b32 v65, 0xffff0000, v32
    v_lshlrev_b32 v66, 16, v33
    v_and_b32 v67, 0xffff0000, v33
L_b_join:
    v_mul_f32 v64, v64, v68
    v_mul_f32 v65, v65, v69
    v_mul_f32 v66, v66, v70
    v_mul_f32 v67, v67, v71
    v_cvt_pk_bf16_f32 v80, v64, v65
    v_cvt_pk_bf16_f32 v81, v66, v67
    ds_write_b64 v225, v[80:81]
    s_waitcnt lgkmcnt(0)
    s_cbranch_execz L_nb_26
    s_barrier
L_nb_26:
    ds_read_b128 v[128:131], v7 offset:0
    ds_read_b128 v[132:135], v8 offset:512
    ds_read_b128 v[136:139], v7 offset:1024
    ds_read_b128 v[140:143], v8 offset:1536
    ds_read_b128 v[144:147], v7 offset:2048
    ds_read_b128 v[148:151], v8 offset:2560
    ds_read_b128 v[152:155], v7 offset:3072
    ds_read_b128 v[156:159], v8 offset:3584
    s_waitcnt lgkmcnt(7)
    v_mfma_f32_16x16x32_bf16 v[20:23], v[96:99], v[128:131], 0
    s_waitcnt lgkmcnt(6)
    v_mfma_f32_16x16x32_bf16 v[20:23], v[100:103], v[132:135], v[20:23]
    s_waitcnt lgkmcnt(5)
    v_mfma_f32_16x16x32_bf16 v[20:23], v[104:107], v[136:139], v[20:23]
    s_waitcnt lgkmcnt(4)
    v_mfma_f32_16x16x32_bf16 v[20:23], v[108:111], v[140:143], v[20:23]
    s_waitcnt lgkmcnt(3)
    v_mfma_f32_16x16x32_bf16 v[20:23], v[112:115], v[144:147], v[20:23]
    s_waitcnt lgkmcnt(2)
    v_mfma_f32_16x16x32_bf16 v[20:23], v[116:119], v[148:151], v[20:23]
    s_waitcnt lgkmcnt(1)
    v_mfma_f32_16x16x32_bf16 v[20:23], v[120:123], v[152:155], v[20:23]
    s_waitcnt lgkmcnt(0)
    v_mfma_f32_16x16x32_bf16 v[20:23], v[124:127], v[156:159], v[20:23]
    s_nop 7
    v_cndmask_b32 v24, v20, v22, s[50:51]
    v_cndmask_b32 v25, v21, v23, s[50:51]
    s_cbranch_execz L_ns_27
    buffer_store_dwordx4 v[24:27], v13, s[36:39], s89 offen sc1
L_ns_27:
    s_add_u32 s53, s2, s28
    s_cmp_lg_u32 s53, 0
    s_cbranch_scc1 L_noep_28
    s_mov_b64 exec, 1
    v_mov_b32 v9, s58
    buffer_store_dword v9, v19, s[36:39], 0 offen sc1
    s_mov_b64 exec, -1
L_noep_28:
    s_cmp_ge_u32 s28, s3
    s_cbranch_scc1 L_b_end2
    s_cbranch_execz L_bell_29_ok
L_bell_29:
    s_mov_b64 exec, 1
    buffer_load_dword v9, v14, s[36:39], s8 offen offset:12 sc1
    s_waitcnt vmcnt(0)
    v_cmpx_eq_u32 vcc, s31, v9
    s_cbranch_execnz L_bell_29_ok
    s_sleep 1
    s_sub_u32 s52, s52, 1
    s_cbranch_scc0 L_bell_29
    s_mov_b32 s52, 0
L_bell_29_ok:
    s_mov_b64 exec, s[94:95]
L_poll_30:
    s_cbranch_execz L_poll_30_nl
    buffer_load_dwordx4 v[32:35], v14, s[36:39], s8 offen sc1
    buffer_load_dwordx4 v[36:39], v14, s[36:39], s9 offen sc1
    buffer_load_dwordx4 v[40:43], v14, s[36:39], s10 offen sc1
    buffer_load_dwordx4 v[44:47], v14, s[36:39], s11 offen sc1
    s_waitcnt vmcnt(0)
L_poll_30_nl:
    v_cmpx_eq_u64 vcc, s[48:49], v[34:35]
    v_cmpx_eq_u64 vcc, s[48:49], v[38:39]
    v_cmpx_eq_u64 vcc, s[48:49], v[42:43]
    v_cmpx_eq_u64 vcc, s[48:49], v[46:47]
    s_cmp_eq_u64 exec, s[94:95]
    s_mov_b64 exec, s[94:95]
    s_cbranch_scc1 L_poll_30_ok
    s_sub_u32 s52, s52, 1
    s_cbranch_scc0 L_poll_30
    s_mov_b32 s52, 0
L_poll_30_ok:
    v_pk_add_f32 v[32:33], v[32:33], v[36:37]
    v_pk_add_f32 v[40:41], v[40:41], v[44:45]
    v_pk_add_f32 v[32:33], v[32:33], v[40:41]
    s_nop 1
    v_permlane32_swap_b32 v32, v33
    s_nop 0
    v_add_f32 v32, v32, v33
    v_mov_b32 v33, v32
    s_nop 1
    v_permlane16_swap_b32 v32, v33
    s_nop 0
    v_add_f32 v32, v32, v33
    v_mov_b32 v33, v32
    s_nop 1
    v_permlane32_swap_b32 v32, v33
    s_nop 0
    v_cvt_pk_bf16_f32 v9, v32, v33
    v_lshlrev_b32 v66, 16, v15
    v_and_b32 v67, 0xffff0000, v15
    v_lshlrev_b32 v64, 16, v9
    v_and_b32 v65, 0xffff0000, v9
    v_add_f32 v64, v64, v66
    v_add_f32 v65, v65, v67
    v_cvt_pk_bf16_f32 v68, v64, v65
    s_and_b64 exec, s[94:95], 0xffff
    s_cbranch_execz L_ns_31
    buffer_store_dword v68, v224, s[44:47], s80 offen
L_ns_31:
    s_mov_b64 exec, s[94:95]
    s_cmp_lg_u32 s59, 0
    s_cbranch_scc1 L_b_real0
L_b_end:
    s_endpgm
L_b_end2:
    s_branch L_b_end
L_roleA:
    v_bfe_u32 v9, v1, 1, 3
    v_xor_b32 v9, v3, v9
    v_lshlrev_b32 v9, 5, v9
    v_and_b32 v4, 1, v1
    v_lshl_add_u32 v9, v4, 4, v9
    v_mul_u32_u24 v4, 256, v3
    v_add_u32 v4, v4, v9
    v_xor_b32 v5, 0x80, v4
    s_lshl_b32 s57, s29, 22
    s_lshr_b32 s55, s30, 2
    s_lshl_b32 s53, s55, 20
    s_add_u32 s57, s57, s53
    s_and_b32 s56, s30, 3
    s_lshl_b32 s53, s56, 16
    s_add_u32 s57, s57, s53
    s_add_u32 s57, s57, 0xc0000
    v_xor_b32 v9, v2, v3
    v_lshlrev_b32 v9, 4, v9
    v_lshl_add_u32 v224, v3, 8, v9
    v_xor_b32 v225, 64, v224
    v_xor_b32 v226, 128, v224
    v_xor_b32 v227, 192, v224
    s_waitcnt lgkmcnt(0)
    s_load_dword s100, s[26:27], 0
    s_mov_b32 s44, s24
    s_and_b32 s45, s25, 0xffff
    s_mov_b32 s46, 0x100
    s_mov_b32 s47, 0x20000
    s_getreg_b32 s97, hwreg(HW_REG_XCC_ID, 0, 4)
    s_add_u32 s97, s97, 1
    s_lshl_b32 s98, s29, 5
    s_cmp_lg_u32 s28, 0
    s_cbranch_scc1 L_noxcc_32
    s_lshr_b32 s54, s2, 3
    s_add_u32 s53, s98, s54
    v_mov_b32 v9, s97
    s_mov_b64 exec, 1
    buffer_store_byte v9, v19, s[44:47], s53 offen sc1
    s_mov_b64 exec, -1
L_noxcc_32:
    s_mul_i32 s97, s97, 0x01010101
    s_cmp_ge_u32 s28, 4
    s_cbranch_scc1 L_a_noissue0
    s_mov_b32 s40, s6
    s_and_b32 s41, s7, 0xffff
    s_mov_b32 s42, 0x2000000
    s_mov_b32 s43, 0x20000
    s_mov_b32 s32, s8
    s_and_b32 s33, s9, 0xffff
    s_mov_b32 s34, 0x2000000
    s_mov_b32 s35, 0x20000
    s_mul_i32 s53, s28, 16384
    s_add_u32 s53, s53, s57
    s_mul_i32 s54, s28, 16384
    s_mov_b32 m0, s54
    s_add_u32 s54, s54, 1024
    buffer_load_dwordx4 v4, s[32:35], s53 offen nt lds
    s_add_u32 s53, s53, 1024
    s_mov_b32 m0, s54
    s_add_u32 s54, s54, 1024
    buffer_load_dwordx4 v4, s[32:35], s53 offen nt lds
    s_add_u32 s53, s53, 1024
    s_mov_b32 m0, s54
    s_add_u32 s54, s54, 1024
    buffer_load_dwordx4 v5, s[32:35], s53 offen nt lds
    s_add_u32 s53, s53, 1024
    s_mov_b32 m0, s54
    s_add_u32 s54, s54, 1024
    buffer_load_dwordx4 v5, s[32:35], s53 offen nt lds
    s_add_u32 s53, s53, 1024
    s_mov_b32 m0, s54
    s_add_u32 s54, s54, 1024
    buffer_load_dwordx4 v4, s[32:35], s53 offen nt lds
    s_add_u32 s53, s53, 1024
    s_mov_b32 m0, s54
    s_add_u32 s54, s54, 1024
    buffer_load_dwordx4 v4, s[32:35], s53 offen nt lds
    s_add_u32 s53, s53, 1024
    s_mov_b32 m0, s54
    s_add_u32 s54, s54, 1024
    buffer_load_dwordx4 v5, s[32:35], s53 offen nt lds
    s_add_u32 s53, s53, 1024
    s_mov_b32 m0, s54
    s_add_u32 s54, s54, 1024
    buffer_load_dwordx4 v5, s[32:35], s53 offen nt lds
    s_add_u32 s53, s53, 1024
    s_mov_b32 m0, s54
    s_add_u32 s54, s54, 1024
    buffer_load_dwordx4 v4, s[32:35], s53 offen nt lds
    s_add_u32 s53, s53, 1024
    s_mov_b32 m0, s54
    s_add_u32 s54, s54, 1024
    buffer_load_dwordx4 v4, s[32:35], s53 offen nt lds
    s_add_u32 s53, s53, 1024
    s_mov_b32 m0, s54
    s_add_u32 s54, s54, 1024
    buffer_load_dwordx4 v5, s[32:35], s53 offen nt lds
    s_add_u32 s53, s53, 1024
    s_mov_b32 m0, s54
    s_add_u32 s54, s54, 1024
    buffer_load_dwordx4 v5, s[32:35], s53 offen nt lds
    s_add_u32 s53, s53, 1024
    s_mov_b32 m0, s54
    s_add_u32 s54, s54, 1024
    buffer_load_dwordx4 v4, s[32:35], s53 offen nt lds
    s_add_u32 s53, s53, 1024
    s_mov_b32 m0, s54
    s_add_u32 s54, s54, 1024
    buffer_load_dwordx4 v4, s[32:35], s53 offen nt lds
    s_add_u32 s53, s53, 1024
    s_mov_b32 m0, s54
    s_add_u32 s54, s54, 1024
    buffer_load_dwordx4 v5, s[32:35], s53 offen nt lds
    s_add_u32 s53, s53, 1024
    s_mov_b32 m0, s54
    s_nop 0
    buffer_load_dwordx4 v5, s[32:35], s53 offen nt lds
    s_mul_i32 s53, s28, 8192
    s_add_u32 s53, s53, s57
    s_mul_i32 s54, s28, 8192
    s_add_u32 s54, s54, 65536
    s_mov_b32 m0, s54
    s_add_u32 s54, s54, 1024
    buffer_load_dwordx4 v224, s[40:43], s53 offen nt lds
    s_add_u32 s53, s53, 1024
    s_mov_b32 m0, s54
    s_add_u32 s54, s54, 1024
    buffer_load_dwordx4 v225, s[40:43], s53 offen nt lds
    s_add_u32 s53, s53, 1024
    s_mov_b32 m0, s54
    s_add_u32 s54, s54, 1024
    buffer_load_dwordx4 v226, s[40:43], s53 offen nt lds
    s_add_u32 s53, s53, 1024
    s_mov_b32 m0, s54
    s_add_u32 s54, s54, 1024
    buffer_load_dwordx4 v227, s[40:43], s53 offen nt lds
    s_add_u32 s53, s53, 1024
    s_mov_b32 m0, s54
    s_add_u32 s54, s54, 1024
    buffer_load_dwordx4 v224, s[40:43], s53 offen nt lds
    s_add_u32 s53, s53, 1024
    s_mov_b32 m0, s54
    s_add_u32 s54, s54, 1024
    buffer_load_dwordx4 v225, s[40:43], s53 offen nt lds
    s_add_u32 s53, s53, 1024
    s_mov_b32 m0, s54
    s_add_u32 s54, s54, 1024
    buffer_load_dwordx4 v226, s[40:43], s53 offen nt lds
    s_add_u32 s53, s53, 1024
    s_mov_b32 m0, s54
    s_nop 0
    buffer_load_dwordx4 v227, s[40:43], s53 offen nt lds
    s_mul_i32 s53, s28, 8192
    s_add_u32 s53, s53, s57
    s_add_u32 s53, s53, 32768
    s_mul_i32 s54, s28, 8192
    s_add_u32 s54, s54, 98304
    s_mov_b32 m0, s54
    s_add_u32 s54, s54, 1024
    buffer_load_dwordx4 v224, s[40:43], s53 offen nt lds
    s_add_u32 s53, s53, 1024
    s_mov_b32 m0, s54
    s_add_u32 s54, s54, 1024
    buffer_load_dwordx4 v225, s[40:43], s53 offen nt lds
    s_add_u32 s53, s53, 1024
    s_mov_b32 m0, s54
    s_add_u32 s54, s54, 1024
    buffer_load_dwordx4 v226, s[40:43], s53 offen nt lds
    s_add_u32 s53, s53, 1024
    s_mov_b32 m0, s54
    s_add_u32 s54, s54, 1024
    buffer_load_dwordx4 v227, s[40:43], s53 offen nt lds
    s_add_u32 s53, s53, 1024
    s_mov_b32 m0, s54
    s_add_u32 s54, s54, 1024
    buffer_load_dwordx4 v224, s[40:43], s53 offen nt lds
    s_add_u32 s53, s53, 1024
    s_mov_b32 m0, s54
    s_add_u32 s54, s54, 1024
    buffer_load_dwordx4 v225, s[40:43], s53 offen nt lds
    s_add_u32 s53, s53, 1024
    s_mov_b32 m0, s54
    s_add_u32 s54, s54, 1024
    buffer_load_dwordx4 v226, s[40:43], s53 offen nt lds
    s_add_u32 s53, s53, 1024
    s_mov_b32 m0, s54
    s_nop 0
    buffer_load_dwordx4 v227, s[40:43], s53 offen nt lds
L_a_noissue0:
    s_mov_b32 s36, s26
    s_and_b32 s37, s27, 0xffff
    s_mov_b32 s38, 0x800000
    s_mov_b32 s39, 0x20000
    s_mov_b32 s52, 0x200000
    s_mov_b32 s50, 0xff00ff00
    s_mov_b32 s51, 0xff00ff00
    s_mov_b64 s[94:95], -1
    s_mov_b32 s59, 0
    v_lshlrev_b32 v18, 4, v1
    v_bfe_u32 v9, v1, 2, 2
    v_and_b32 v6, 1, v3
    v_lshl_or_b32 v6, v6, 2, v9
    v_xor_b32 v6, s28, v6
    v_lshlrev_b32 v6, 5, v6
    v_lshl_add_u32 v9, v3, 3, v9
    v_lshl_add_u32 v6, v9, 8, v6
    v_and_b32 v9, 3, v1
    v_lshl_add_u32 v6, v9, 3, v6
    v_xor_b32 v9, v2, v3
    v_lshlrev_b32 v9, 4, v9
    v_lshl_add_u32 v9, v2, 8, v9
    s_lshl_b32 s53, s28, 13
    s_add_u32 s53, s53, 65536
    v_add_u32 v228, s53, v9
    v_xor_b32 v229, 64, v228
    v_xor_b32 v230, 128, v228
    v_xor_b32 v231, 192, v228
    v_and_b32 v9, 7, v1
    v_lshlrev_b32 v232, 1, v3
    v_xor_b32 v232, v232, v9
    v_lshlrev_b32 v232, 4, v232
    v_lshl_add_u32 v232, v3, 7, v232
    v_add_u32 v232, 147456, v232
    v_xor_b32 v233, 16, v232
    v_and_b32 v9, 7, v1
    v_lshlrev_b32 v7, 1, v3
    v_xor_b32 v7, v7, v9
    v_lshlrev_b32 v7, 4, v7
    v_lshl_add_u32 v7, v3, 7, v7
    v_add_u32 v7, 149504, v7
    v_xor_b32 v8, 16, v7
    v_bfe_u32 v11, v1, 2, 3
    v_and_b32 v9, 3, v11
    v_lshlrev_b32 v9, 1, v9
    v_bfe_u32 v10, v11, 2, 1
    v_or_b32 v9, v9, v10
    v_xor_b32 v9, s28, v9
    v_lshlrev_b32 v9, 4, v9
    v_lshrrev_b32 v10, 2, v1
    v_lshl_add_u32 v9, v10, 7, v9
    v_and_b32 v10, 3, v1
    v_lshl_add_u32 v9, v10, 2, v9
    v_add_u32 v234, 147456, v9
    v_and_b32 v9, 2, v3
    s_and_b32 s53, s28, 1
    v_or_b32 v9, s53, v9
    v_and_b32 v10, 7, v1
    v_xor_b32 v9, v9, v10
    v_lshlrev_b32 v9, 4, v9
    v_lshrrev_b32 v10, 1, v3
    v_lshl_add_u32 v9, v10, 7, v9
    v_and_b32 v10, 1, v3
    v_lshl_add_u32 v9, v10, 3, v9
    s_lshl_b32 s53, s28, 9
    s_add_u32 s53, s53, 149504
    v_add_u32 v235, s53, v9
    v_xor_b32 v236, 64, v235
    v_add_u32 v236, 0x100, v236
    v_cndmask_b32 v235, v235, v236, s[50:51]
    v_and_b32 v9, 7, v1
    v_lshlrev_b32 v239, 2, v9
    v_lshlrev_b32 v9, 6, v9
    v_add_u32 v238, 153600, v9
    s_lshl_b32 s53, s28, 2
    v_add_u32 v237, s53, v238
    s_lshl_b32 s53, s55, 3
    s_add_u32 s53, s53, s28
    s_lshl_b32 s53, s53, 15
    s_lshl_b32 s54, s29, 10
    s_add_u32 s53, s53, s54
    s_add_u32 s80, s53, 0x100000
    s_add_u32 s81, s80, 8192
    s_add_u32 s82, s80, 16384
    s_add_u32 s83, s80, 24576
    s_lshl_b32 s53, s55, 3
    s_add_u32 s53, s53, s29
    s_lshl_b32 s53, s53, 14
    s_add_u32 s53, s53, 0x200000
    s_lshl_b32 s54, s56, 10
    s_add_u32 s87, s53, s54
    s_add_u32 s88, s87, 4096
    s_add_u32 s89, s87, 8192
    s_add_u32 s90, s87, 12288
    s_lshl_b32 s54, s56, 12
    s_add_u32 s53, s53, s54
    s_lshl_b32 s54, s28, 6
    s_add_u32 s84, s53, s54
    v_and_b32 v9, 7, v1
    v_lshlrev_b32 v13, 9, v9
    v_lshl_add_u32 v13, v3, 4, v13
    s_lshl_b32 s53, s30, 3
    s_add_u32 s53, s53, s29
    s_lshl_b32 s53, s53, 10
    s_add_u32 s91, s53, 0x2e0000
    s_mov_b32 s96, 0x3fb8aa3b
    s_cmp_lt_u32 s28, 4
    s_cbranch_scc1 L_a_real
    s_mov_b64 s[94:95], 0
    s_mov_b64 s[62:63], 0
    s_mov_b64 s[92:93], 0
    s_mov_b32 s59, 1
    s_mov_b32 s3, 8
    s_mov_b64 exec, s[94:95]
    s_branch L_a_att
L_a_real0:
    s_mov_b64 s[94:95], -1
    s_mov_b32 s59, 0
    s_mov_b32 s3, 2
    s_mov_b64 exec, s[94:95]
    s_cmp_lg_u32 s28, 4
    s_cbranch_scc1 L_a_notouch
    v_and_b32 v9, 7, v1
    v_lshlrev_b32 v9, 7, v9
    v_bfe_u32 v10, v1, 3, 2
    v_lshl_add_u32 v9, v10, 12, v9
    buffer_load_dword v244, v9, s[36:39], s87 offen offset:0 sc1
    buffer_load_dword v245, v19, s[36:39], s80 offen offset:0 sc1
    buffer_load_dword v246, v19, s[36:39], s91 offen offset:0 sc1
    v_min_u32 v10, 27, v1
    v_lshlrev_b32 v10, 18, v10
    global_load_dword v247, v10, s[16:17]
    global_load_dword v247, v10, s[18:19]
    s_mov_b32 s53, 0x280000
    s_mov_b32 s54, 0x500000
    buffer_load_dword v247, v19, s[36:39], s54 offen offset:64 sc1
L_a_notouch:
L_a_real:
    s_mov_b64 s[94:95], -1
    s_mov_b32 s59, 0
    s_mov_b32 s3, 2
    s_mov_b64 exec, s[94:95]
    s_waitcnt lgkmcnt(0)
    s_mov_b32 s58, s100
    s_mul_i32 s31, s58, 0x9e3779b1
    s_add_u32 s31, s31, 0x85ebca6b
    s_mov_b32 s48, s31
    s_mov_b32 s49, s31
    s_add_u32 s58, s58, 1
    v_mov_b32 v26, s31
    v_mov_b32 v27, s31
    s_lshr_b32 s56, s16, 7
    s_mul_i32 s53, s29, 7
    s_add_u32 s56, s56, s53
    s_sub_u32 s56, 3, s56
    s_and_b32 s56, s56, 7
    s_mov_b32 s101, 0
    s_cmp_ge_u32 s30, 7
    s_cselect_b32 s54, 7, 0
    s_cselect_b32 s100, 1, 0
    s_sub_u32 s55, s30, s54
    s_cmp_eq_u32 s55, s56
    s_cselect_b32 s99, 1, 0
    s_cmp_lt_u32 s30, 14
    s_cbranch_scc1 L_a_nohelp
    s_cmp_eq_u32 s56, 7
    s_cselect_b32 s101, 1, 0
    s_mov_b32 s55, s56
    s_sub_u32 s100, s30, 14
    s_mov_b32 s99, 2
L_a_nohelp:
    s_cmp_lg_u32 s100, 0
    s_cselect_b32 s32, s18, s16
    s_cselect_b32 s53, s19, s17
    s_cselect_b32 s85, 0x20000, 0
    s_add_u32 s85, s85, 0x290000
    s_and_b32 s33, s53, 0xffff
    s_cmp_lg_u32 s101, 0
    s_cselect_b32 s34, 0, 0x700000
    s_mov_b32 s35, 0x20000
    s_mul_i32 s53, s29, 7
    s_add_u32 s55, s55, s53
    v_lshrrev_b32 v9, 3, v1
    v_bfe_u32 v10, v1, 4, 1
    v_and_b32 v11, 7, v1
    v_xor_b32 v10, v10, v11
    v_lshlrev_b32 v10, 4, v10
    v_mul_u32_u24 v248, 7168, v9
    v_add_u32 v248, v248, v10
    v_xor_b32 v249, 32, v248
    v_xor_b32 v250, 64, v248
    v_xor_b32 v251, 96, v248
    s_and_b32 s53, s28, 1
    s_lshl_b32 s53, s53, 6
    v_xor_b32 v252, s53, v248
    v_xor_b32 v253, 32, v252
    s_cmp_eq_u32 s99, 2
    s_cselect_b32 s54, 64, 0
    s_mul_i32 s53, s28, 0
    s_add_u32 s53, s53, s54
    s_lshl_b32 s9, s53, 10
    s_mul_i32 s8, s53, 57344
    s_lshl_b32 s57, s55, 7
    s_add_u32 s8, s8, s57
    s_cmp_eq_u32 s99, 0
    s_cselect_b32 s53, 32, 16
    s_cselect_b32 s6, 4, 2
    s_mul_i32 s53, s53, s28
    s_add_u32 s53, s53, s54
    s_add_u32 s53, s53, 0
    s_lshl_b32 s5, s53, 10
    s_mul_i32 s4, s53, 57344
    s_add_u32 s4, s4, s57
    s_waitcnt vmcnt(8)
    s_cmp_lg_u32 s28, 0
    s_cbranch_scc1 L_notr_33
    s_lshl_b32 s53, s30, 3
    s_or_b32 s53, s53, s29
    s_lshl_b32 s53, s53, 7
    s_add_u32 s53, s53, 0x4000
    s_mov_b64 exec, 1
    buffer_store_dwordx2 v[26:27], v19, s[36:39], s53 offen sc1
    s_mov_b64 exec, -1
L_notr_33:
    s_waitcnt vmcnt(16)
    s_barrier
    ds_read_b64_tr_b16 v[96:97], v6 offset:0
    ds_read_b64_tr_b16 v[98:99], v6 offset:1024
    ds_read_b64_tr_b16 v[100:101], v6 offset:8192
    ds_read_b64_tr_b16 v[102:103], v6 offset:9216
    ds_read_b64_tr_b16 v[104:105], v6 offset:16384
    ds_read_b64_tr_b16 v[106:107], v6 offset:17408
    ds_read_b64_tr_b16 v[108:109], v6 offset:24576
    ds_read_b64_tr_b16 v[110:111], v6 offset:25600
    ds_read_b64_tr_b16 v[112:113], v6 offset:32768
    ds_read_b64_tr_b16 v[114:115], v6 offset:33792
    ds_read_b64_tr_b16 v[116:117], v6 offset:40960
    ds_read_b64_tr_b16 v[118:119], v6 offset:41984
    ds_read_b64_tr_b16 v[120:121], v6 offset:49152
    ds_read_b64_tr_b16 v[122:123], v6 offset:50176
    ds_read_b64_tr_b16 v[124:125], v6 offset:57344
    ds_read_b64_tr_b16 v[126:127], v6 offset:58368
L_a_att:
    s_cbranch_execz L_a_h1k
    s_waitcnt vmcnt(2)
    s_barrier
    buffer_load_dwordx4 v[32:35], v18, s[36:39], s80 offen sc1
    buffer_load_dwordx4 v[36:39], v18, s[36:39], s81 offen sc1
    buffer_load_dwordx4 v[40:43], v18, s[36:39], s82 offen sc1
    buffer_load_dwordx4 v[44:47], v18, s[36:39], s83 offen sc1
    buffer_load_dword v48, v239, s[44:47], s98 offen sc1
    s_waitcnt vmcnt(5)
    s_barrier
L_a_h1k:
    ds_read_b128 v[192:195], v228 offset:0
    ds_read_b128 v[208:211], v228 offset:4096
    ds_read_b128 v[196:199], v229 offset:0
    ds_read_b128 v[212:215], v229 offset:4096
    ds_read_b128 v[200:203], v230 offset:0
    ds_read_b128 v[216:219], v230 offset:4096
    ds_read_b128 v[204:207], v231 offset:0
    ds_read_b128 v[220:223], v231 offset:4096
    s_cbranch_execz L_a_h1_nl
    s_branch L_a_h1w
L_a_h1:
    buffer_load_dwordx4 v[32:35], v18, s[36:39], s80 offen sc1
    buffer_load_dwordx4 v[36:39], v18, s[36:39], s81 offen sc1
    buffer_load_dwordx4 v[40:43], v18, s[36:39], s82 offen sc1
    buffer_load_dwordx4 v[44:47], v18, s[36:39], s83 offen sc1
    buffer_load_dword v48, v239, s[44:47], s98 offen sc1
L_a_h1w:
    s_waitcnt vmcnt(0)
L_a_h1_nl:
    v_cmpx_eq_u64 vcc, s[48:49], v[34:35]
    v_cmpx_eq_u64 vcc, s[48:49], v[38:39]
    v_cmpx_eq_u64 vcc, s[48:49], v[42:43]
    v_cmpx_eq_u64 vcc, s[48:49], v[46:47]
    v_subrev_u32 v9, 0x01010101, v48
    v_bfi_b32 v9, v48, 0, v9
    v_and_b32 v9, 0x80808080, v9
    v_cmpx_eq_u32 vcc, 0, v9
    s_cmp_eq_u64 exec, s[94:95]
    s_mov_b64 exec, s[94:95]
    s_cbranch_scc1 L_a_h1_ok
    s_sub_u32 s52, s52, 1
    s_cbranch_scc0 L_a_h1
    s_mov_b32 s52, 0
L_a_h1_ok:
    v_pk_add_f32 v[32:33], v[32:33], v[36:37]
    v_pk_add_f32 v[40:41], v[40:41], v[44:45]
    v_pk_add_f32 v[32:33], v[32:33], v[40:41]
    v_cvt_pk_bf16_f32 v9, v32, v33
    ds_write_b32 v234, v9
    v_cmp_ne_u32 vcc, s97, v48
    s_nop 1
    s_cmp_eq_u64 vcc, 0
    s_cselect_b64 s[62:63], s[94:95], 0
    s_cselect_b64 s[92:93], 0, s[94:95]
    s_waitcnt lgkmcnt(0)
    s_cbranch_execz L_nb_34
    s_barrier
L_nb_34:
    ds_read_b128 v[128:131], v232 offset:0
    ds_read_b128 v[132:135], v233 offset:512
    ds_read_b128 v[136:139], v232 offset:1024
    ds_read_b128 v[140:143], v233 offset:1536
    s_waitcnt lgkmcnt(3)
    v_mfma_f32_16x16x32_bf16 v[64:67], v[192:195], v[128:131], 0
    v_mfma_f32_16x16x32_bf16 v[68:71], v[208:211], v[128:131], 0
    s_waitcnt lgkmcnt(2)
    v_mfma_f32_16x16x32_bf16 v[64:67], v[196:199], v[132:135], v[64:67]
    v_mfma_f32_16x16x32_bf16 v[68:71], v[212:215], v[132:135], v[68:71]
    s_waitcnt lgkmcnt(1)
    v_mfma_f32_16x16x32_bf16 v[64:67], v[200:203], v[136:139], v[64:67]
    v_mfma_f32_16x16x32_bf16 v[68:71], v[216:219], v[136:139], v[68:71]
    s_waitcnt lgkmcnt(0)
    v_mfma_f32_16x16x32_bf16 v[64:67], v[204:207], v[140:143], v[64:67]
    v_mfma_f32_16x16x32_bf16 v[68:71], v[220:223], v[140:143], v[68:71]
    s_nop 7
    v_cndmask_b32 v72, v64, v68, s[50:51]
    v_cndmask_b32 v73, v65, v69, s[50:51]
    v_cndmask_b32 v74, v66, v70, s[50:51]
    v_cndmask_b32 v75, v67, v71, s[50:51]
    v_cvt_pk_bf16_f32 v80, v72, v73
    v_cvt_pk_bf16_f32 v81, v74, v75
    v_lshlrev_b32 v72, 16, v80
    v_and_b32 v73, 0xffff0000, v80
    v_lshlrev_b32 v74, 16, v81
    v_and_b32 v75, 0xffff0000, v81
    v_mul_f32 v72, 0x3db504f3, v72
    v_mul_f32 v73, 0x3db504f3, v73
    v_mul_f32 v74, 0x3db504f3, v74
    v_mul_f32 v75, 0x3db504f3, v75
    v_cvt_pk_bf16_f32 v80, v72, v73
    v_cvt_pk_bf16_f32 v81, v74, v75
    v_lshlrev_b32 v72, 16, v80
    v_and_b32 v73, 0xffff0000, v80
    v_lshlrev_b32 v74, 16, v81
    v_and_b32 v75, 0xffff0000, v81
    v_max3_f32 v28, v72, v73, v74
    v_max_f32 v28, v28, v75
    s_nop 1
    v_max_f32_dpp v28, v28, v28 row_ror:8 row_mask:0xf bank_mask:0xf
    v_mov_b32 v9, v28
    s_nop 1
    v_permlane16_swap_b32 v28, v9
    s_nop 0
    v_max_f32 v28, v28, v9
    v_mov_b32 v9, v28
    s_nop 1
    v_permlane32_swap_b32 v28, v9
    s_nop 0
    v_max_f32 v28, v28, v9
    v_mul_f32 v28, s96, v28
    v_fma_f32 v72, v72, s96, -v28
    v_fma_f32 v73, v73, s96, -v28
    v_fma_f32 v74, v74, s96, -v28
    v_fma_f32 v75, v75, s96, -v28
    v_exp_f32 v72, v72
    v_exp_f32 v73, v73
    v_exp_f32 v74, v74
    v_exp_f32 v75, v75
    s_nop 0
    v_cvt_pk_bf16_f32 v80, v72, v73
    v_cvt_pk_bf16_f32 v81, v74, v75
    v_add_f32 v31, v72, v73
    v_add_f32 v10, v74, v75
    ds_write_b64 v235, v[80:81]
    v_add_f32 v31, v31, v10
    s_nop 1
    v_add_f32_dpp v31, v31, v31 row_ror:8 row_mask:0xf bank_mask:0xf
    v_mov_b32 v9, v31
    s_nop 1
    v_permlane16_swap_b32 v31, v9
    s_nop 0
    v_add_f32 v31, v31, v9
    v_mov_b32 v9, v31
    s_nop 1
    v_permlane32_swap_b32 v31, v9
    s_nop 0
    v_add_f32 v31, v31, v9
    ds_write2_b32 v237, v28, v31 offset0:0 offset1:8
    s_waitcnt lgkmcnt(0)
    s_cbranch_execz L_nb_35
    s_barrier
L_nb_35:
    ds_read_b128 v[32:35], v238 offset:0
    ds_read_b128 v[36:39], v238 offset:16
    ds_read_b128 v[40:43], v238 offset:32
    ds_read_b128 v[44:47], v238 offset:48
    ds_read_b128 v[128:131], v7 offset:0
    ds_read_b128 v[132:135], v8 offset:512
    ds_read_b128 v[136:139], v7 offset:1024
    ds_read_b128 v[140:143], v8 offset:1536
    ds_read_b128 v[144:147], v7 offset:2048
    ds_read_b128 v[148:151], v8 offset:2560
    ds_read_b128 v[152:155], v7 offset:3072
    ds_read_b128 v[156:159], v8 offset:3584
    s_waitcnt lgkmcnt(7)
    v_mfma_f32_16x16x32_bf16 v[64:67], v[96:99], v[128:131], 0
    v_max3_f32 v28, v32, v33, v34
    v_max3_f32 v9, v35, v36, v37
    v_max3_f32 v28, v28, v38, v39
    v_max_f32 v28, v28, v9
    v_sub_f32 v32, v32, v28
    s_waitcnt lgkmcnt(6)
    v_mfma_f32_16x16x32_bf16 v[68:71], v[100:103], v[132:135], 0
    v_sub_f32 v33, v33, v28
    v_sub_f32 v34, v34, v28
    v_sub_f32 v35, v35, v28
    v_sub_f32 v36, v36, v28
    v_sub_f32 v37, v37, v28
    s_waitcnt lgkmcnt(5)
    v_mfma_f32_16x16x32_bf16 v[72:75], v[104:107], v[136:139], 0
    v_sub_f32 v38, v38, v28
    v_sub_f32 v39, v39, v28
    v_exp_f32 v32, v32
    v_exp_f32 v33, v33
    v_exp_f32 v34, v34
    s_waitcnt lgkmcnt(4)
    v_mfma_f32_16x16x32_bf16 v[76:79], v[108:111], v[140:143], 0
    v_exp_f32 v35, v35
    v_exp_f32 v36, v36
    v_exp_f32 v37, v37
    v_exp_f32 v38, v38
    v_exp_f32 v39, v39
    s_waitcnt lgkmcnt(3)
    v_mfma_f32_16x16x32_bf16 v[80:83], v[112:115], v[144:147], 0
    v_mul_f32 v31, v40, v32
    v_mul_f32 v10, v41, v33
    v_fmac_f32 v31, v42, v34
    v_fmac_f32 v10, v43, v35
    v_fmac_f32 v31, v44, v36
    s_waitcnt lgkmcnt(2)
    v_mfma_f32_16x16x32_bf16 v[84:87], v[116:119], v[148:151], 0
    v_fmac_f32 v10, v45, v37
    v_fmac_f32 v31, v46, v38
    v_fmac_f32 v10, v47, v39
    v_add_f32 v31, v31, v10
    v_rcp_f32 v29, v31
    s_waitcnt lgkmcnt(1)
    v_mfma_f32_16x16x32_bf16 v[88:91], v[120:123], v[152:155], 0
    v_log_f32 v10, v31
    s_nop 0
    v_add_f32 v26, v10, v28
    s_waitcnt lgkmcnt(0)
    v_mfma_f32_16x16x32_bf16 v[92:95], v[124:127], v[156:159], 0
    v_pk_mul_f32 v[20:21], v[64:65], v[32:33] op_sel:[0,0] op_sel_hi:[1,0]
    v_pk_mul_f32 v[22:23], v[66:67], v[32:33] op_sel:[0,0] op_sel_hi:[1,0]
    v_pk_fma_f32 v[20:21], v[68:69], v[32:33], v[20:21] op_sel:[0,1,0] op_sel_hi:[1,1,1]
    v_pk_fma_f32 v[22:23], v[70:71], v[32:33], v[22:23] op_sel:[0,1,0] op_sel_hi:[1,1,1]
    v_pk_fma_f32 v[20:21], v[72:73], v[34:35], v[20:21] op_sel:[0,0,0] op_sel_hi:[1,0,1]
    v_pk_fma_f32 v[22:23], v[74:75], v[34:35], v[22:23] op_sel:[0,0,0] op_sel_hi:[1,0,1]
    v_pk_fma_f32 v[20:21], v[76:77], v[34:35], v[20:21] op_sel:[0,1,0] op_sel_hi:[1,1,1]
    v_pk_fma_f32 v[22:23], v[78:79], v[34:35], v[22:23] op_sel:[0,1,0] op_sel_hi:[1,1,1]
    v_pk_fma_f32 v[20:21], v[80:81], v[36:37], v[20:21] op_sel:[0,0,0] op_sel_hi:[1,0,1]
    v_pk_fma_f32 v[22:23], v[82:83], v[36:37], v[22:23] op_sel:[0,0,0] op_sel_hi:[1,0,1]
    v_pk_fma_f32 v[20:21], v[84:85], v[36:37], v[20:21] op_sel:[0,1,0] op_sel_hi:[1,1,1]
    v_pk_fma_f32 v[22:23], v[86:87], v[36:37], v[22:23] op_sel:[0,1,0] op_sel_hi:[1,1,1]
    v_pk_fma_f32 v[20:21], v[88:89], v[38:39], v[20:21] op_sel:[0,0,0] op_sel_hi:[1,0,1]
    v_pk_fma_f32 v[22:23], v[90:91], v[38:39], v[22:23] op_sel:[0,0,0] op_sel_hi:[1,0,1]
    v_pk_fma_f32 v[20:21], v[92:93], v[38:39], v[20:21] op_sel:[0,1,0] op_sel_hi:[1,1,1]
    v_pk_fma_f32 v[22:23], v[94:95], v[38:39], v[22:23] op_sel:[0,1,0] op_sel_hi:[1,1,1]
    v_pk_mul_f32 v[20:21], v[20:21], v[28:29] op_sel:[0,1] op_sel_hi:[1,1]
    v_pk_mul_f32 v[22:23], v[22:23], v[28:29] op_sel:[0,1] op_sel_hi:[1,1]
    v_cvt_pk_bf16_f32 v24, v20, v21
    v_cvt_pk_bf16_f32 v25, v22, v23
    s_andn2_b64 exec, s[62:63], s[50:51]
    s_cbranch_execz L_ns_36
    buffer_store_dwordx4 v[24:27], v13, s[36:39], s84 offen
L_ns_36:
    s_andn2_b64 exec, s[92:93], s[50:51]
    s_cbranch_execz L_ns_37
    buffer_store_dwordx4 v[24:27], v13, s[36:39], s84 offen sc1
L_ns_37:
    s_mov_b64 exec, s[94:95]
    s_sub_u32 s53, s28, 1
    s_cmp_lt_u32 s53, 3
    s_cbranch_scc1 L_a_nocomb
    s_cmp_lg_u32 s59, 0
    s_cbranch_scc1 L_a_comb
    s_cmp_lg_u32 s28, 0
    s_cbranch_scc1 L_a_nocomb
L_a_comb:
L_poll_38:
    s_cbranch_execz L_poll_38_nl
    buffer_load_dwordx4 v[32:35], v18, s[36:39], s87 offen sc1
    buffer_load_dwordx4 v[36:39], v18, s[36:39], s88 offen sc1
    buffer_load_dwordx4 v[40:43], v18, s[36:39], s89 offen sc1
    buffer_load_dwordx4 v[44:47], v18, s[36:39], s90 offen sc1
    s_waitcnt vmcnt(0)
L_poll_38_nl:
    v_cmpx_eq_u32 vcc, s31, v35
    v_cmpx_eq_u32 vcc, s31, v39
    v_cmpx_eq_u32 vcc, s31, v43
    v_cmpx_eq_u32 vcc, s31, v47
    s_cmp_eq_u64 exec, s[94:95]
    s_mov_b64 exec, s[94:95]
    s_cbranch_scc1 L_poll_38_ok
    s_sub_u32 s52, s52, 1
    s_cbranch_scc0 L_poll_38
    s_mov_b32 s52, 0
L_poll_38_ok:
    v_max3_f32 v9, v34, v38, v42
    v_max_f32 v9, v9, v46
    v_sub_f32 v34, v34, v9
    v_sub_f32 v38, v38, v9
    v_sub_f32 v42, v42, v9
    v_sub_f32 v46, v46, v9
    v_exp_f32 v34, v34
    v_exp_f32 v38, v38
    v_exp_f32 v42, v42
    v_exp_f32 v46, v46
    v_lshlrev_b32 v64, 16, v32
    v_and_b32 v65, 0xffff0000, v32
    v_lshlrev_b32 v66, 16, v33
    v_and_b32 v67, 0xffff0000, v33
    v_lshlrev_b32 v68, 16, v36
    v_and_b32 v69, 0xffff0000, v36
    v_lshlrev_b32 v70, 16, v37
    v_and_b32 v71, 0xffff0000, v37
    v_lshlrev_b32 v72, 16, v40
    v_and_b32 v73, 0xffff0000, v40
    v_lshlrev_b32 v74, 16, v41
    v_and_b32 v75, 0xffff0000, v41
    v_lshlrev_b32 v76, 16, v44
    v_and_b32 v77, 0xffff0000, v44
    v_lshlrev_b32 v78, 16, v45
    v_and_b32 v79, 0xffff0000, v45
    v_add_f32 v9, v34, v38
    v_add_f32 v10, v42, v46
    v_add_f32 v9, v9, v10
    v_rcp_f32 v9, v9
    v_mul_f32 v64, v64, v34
    v_mul_f32 v65, v65, v34
    v_mul_f32 v66, v66, v34
    v_mul_f32 v67, v67, v34
    v_fmac_f32 v64, v68, v38
    v_fmac_f32 v65, v69, v38
    v_fmac_f32 v66, v70, v38
    v_fmac_f32 v67, v71, v38
    v_fmac_f32 v64, v72, v42
    v_fmac_f32 v65, v73, v42
    v_fmac_f32 v66, v74, v42
    v_fmac_f32 v67, v75, v42
    v_fmac_f32 v64, v76, v46
    v_fmac_f32 v65, v77, v46
    v_fmac_f32 v66, v78, v46
    v_fmac_f32 v67, v79, v46
    v_mul_f32 v64, v64, v9
    v_mul_f32 v65, v65, v9
    v_mul_f32 v66, v66, v9
    v_mul_f32 v67, v67, v9
    v_cvt_pk_bf16_f32 v80, v64, v65
    v_cvt_pk_bf16_f32 v81, v66, v67
    v_mov_b32 v82, s31
    v_mov_b32 v83, s31
    s_cbranch_execz L_ns_39
    buffer_store_dwordx4 v[80:83], v18, s[36:39], s91 offen sc1
L_ns_39:
L_a_nocomb:
    s_cbranch_execz L_a_gud
    s_cmp_lg_u32 s101, 0
    s_cbranch_scc1 L_a_idle
    s_mov_b32 s96, s100
    s_mov_b32 s53, s4
    s_mov_b32 s54, s5
    s_mov_b32 s56, s6
    s_barrier
    s_cmp_ge_u32 s28, 4
    s_cbranch_scc1 L_a_gusetup
    s_branch L_a_guld
L_a_gud:
    s_mov_b32 s56, 1
L_a_guld:
    s_mov_b32 m0, s54
    s_add_u32 s54, s54, 1024
    s_cbranch_execz L_sk_40
    buffer_load_dwordx4 v248, s[32:35], s53 offen nt lds
L_sk_40:
    s_add_u32 s53, s53, 57344
    s_mov_b32 m0, s54
    s_add_u32 s54, s54, 1024
    s_cbranch_execz L_sk_41
    buffer_load_dwordx4 v249, s[32:35], s53 offen nt lds
L_sk_41:
    s_add_u32 s53, s53, 57344
    s_mov_b32 m0, s54
    s_add_u32 s54, s54, 1024
    s_cbranch_execz L_sk_42
    buffer_load_dwordx4 v248, s[32:35], s53 offen nt lds
L_sk_42:
    s_add_u32 s53, s53, 57344
    s_mov_b32 m0, s54
    s_add_u32 s54, s54, 1024
    s_cbranch_execz L_sk_43
    buffer_load_dwordx4 v249, s[32:35], s53 offen nt lds
L_sk_43:
    s_add_u32 s53, s53, 57344
    s_mov_b32 m0, s54
    s_add_u32 s54, s54, 1024
    s_cbranch_execz L_sk_44
    buffer_load_dwordx4 v250, s[32:35], s53 offen nt lds
L_sk_44:
    s_add_u32 s53, s53, 57344
    s_mov_b32 m0, s54
    s_add_u32 s54, s54, 1024
    s_cbranch_execz L_sk_45
    buffer_load_dwordx4 v251, s[32:35], s53 offen nt lds
L_sk_45:
    s_add_u32 s53, s53, 57344
    s_mov_b32 m0, s54
    s_add_u32 s54, s54, 1024
    s_cbranch_execz L_sk_46
    buffer_load_dwordx4 v250, s[32:35], s53 offen nt lds
L_sk_46:
    s_add_u32 s53, s53, 57344
    s_mov_b32 m0, s54
    s_add_u32 s54, s54, 1024
    s_cbranch_execz L_sk_47
    buffer_load_dwordx4 v251, s[32:35], s53 offen nt lds
L_sk_47:
    s_add_u32 s53, s53, 57344
    s_sub_u32 s56, s56, 1
    s_cmp_lg_u32 s56, 0
    s_cbranch_scc1 L_a_guld
    s_cbranch_execz L_a_real0
L_a_gusetup:
    v_bfe_u32 v9, v1, 3, 1
    v_and_b32 v10, 1, v3
    v_lshl_or_b32 v9, v10, 1, v9
    v_bfe_u32 v10, v1, 1, 1
    v_lshl_or_b32 v9, v10, 2, v9
    v_xor_b32 v9, s28, v9
    v_lshlrev_b32 v9, 4, v9
    v_bfe_u32 v11, v1, 2, 2
    v_lshl_add_u32 v11, v3, 3, v11
    v_lshl_add_u32 v11, v10, 5, v11
    v_lshl_add_u32 v9, v11, 7, v9
    v_and_b32 v10, 1, v1
    v_lshl_add_u32 v6, v10, 3, v9
    v_add_u32 v4, 0x10000, v6
    v_lshrrev_b32 v9, 3, v2
    v_lshl_or_b32 v10, v3, 1, v9
    v_and_b32 v11, 7, v1
    v_xor_b32 v10, v10, v11
    v_lshlrev_b32 v10, 4, v10
    v_lshl_add_u32 v9, v9, 2, v3
    v_lshl_add_u32 v10, v9, 7, v10
    v_add_u32 v7, 131072, v10
    v_lshlrev_b32 v11, 3, v11
    v_add_u32 v8, 153600, v11
    s_lshl_b32 s53, s28, 3
    s_add_u32 s53, s53, 153600
    v_mov_b32 v14, s53
    v_bfe_u32 v11, v1, 1, 3
    v_and_b32 v9, 3, v11
    v_lshlrev_b32 v9, 1, v9
    v_bfe_u32 v10, v11, 2, 1
    v_or_b32 v9, v9, v10
    v_xor_b32 v9, s28, v9
    v_lshlrev_b32 v9, 4, v9
    v_lshrrev_b32 v10, 1, v1
    v_lshl_add_u32 v9, v10, 7, v9
    v_and_b32 v10, 1, v1
    v_lshl_add_u32 v9, v10, 3, v9
    v_add_u32 v17, 131072, v9
    s_lshl_b32 s53, s28, 12
    s_add_u32 s86, s53, 0x280000
    s_lshl_b32 s53, s55, 11
    s_lshl_b32 s54, s28, 8
    s_add_u32 s53, s53, s54
    s_add_u32 s85, s85, s53
    v_and_b32 v9, 1, v3
    v_lshlrev_b32 v13, 7, v9
    v_and_b32 v9, 7, v1
    v_lshl_add_u32 v13, v9, 4, v13
    v_lshrrev_b32 v9, 1, v3
    v_lshl_add_u32 v13, v9, 3, v13
    s_lshl_b32 s53, s96, 1
    s_add_u32 s53, s53, s99
    s_sub_u32 s53, s53, 1
    s_lshl_b32 s53, s53, 3
    s_add_u32 s53, s53, s29
    s_lshl_b32 s53, s53, 12
    s_lshl_b32 s54, s28, 9
    s_add_u32 s53, s53, s54
    s_add_u32 s84, s53, 0x500000
    v_lshlrev_b32 v15, 1, v13
    v_mov_b32 v26, s31
    v_mov_b32 v27, s31
    v_mov_b32 v96, 0x3f803f80
    v_mov_b32 v97, 0x3f803f80
    v_mov_b32 v98, 0x3f803f80
    v_mov_b32 v99, 0x3f803f80
    v_mov_b32 v25, s31
    s_mov_b64 s[80:81], s[62:63]
    s_mov_b64 s[82:83], s[92:93]
    s_cmp_lt_u32 s28, 4
    s_cbranch_scc1 L_a_gureal
    s_mov_b64 s[94:95], 0
    s_mov_b64 s[62:63], 0
    s_mov_b64 s[92:93], 0
    s_mov_b32 s59, 1
    s_mov_b32 s3, 8
    s_mov_b64 exec, s[94:95]
    s_branch L_a_gutop
L_a_gureal:
    s_mov_b64 s[94:95], -1
    s_mov_b32 s59, 0
    s_mov_b32 s3, 2
    s_mov_b64 exec, s[94:95]
    s_mov_b64 s[62:63], s[80:81]
    s_mov_b64 s[92:93], s[82:83]
    s_waitcnt vmcnt(12)
    s_cmp_lg_u32 s28, 0
    s_cbranch_scc1 L_nt2_48
    s_lshl_b32 s53, s30, 3
    s_or_b32 s53, s53, s29
    s_lshl_b32 s53, s53, 7
    s_add_u32 s53, s53, 0x4000
    s_and_b64 exec, s[94:95], 1
    s_cbranch_execz L_ns_49
    buffer_store_dword v27, v19, s[36:39], s53 offen offset:8 sc1
L_ns_49:
    s_mov_b64 exec, s[94:95]
L_nt2_48:
    s_waitcnt vmcnt(0)
    s_barrier
L_a_gutop:
    ds_read_b64_tr_b16 v[192:193], v6 offset:0
    ds_read_b64_tr_b16 v[194:195], v6 offset:512
    ds_read_b64_tr_b16 v[196:197], v6 offset:8192
    ds_read_b64_tr_b16 v[198:199], v6 offset:8704
    ds_read_b64_tr_b16 v[200:201], v6 offset:16384
    ds_read_b64_tr_b16 v[202:203], v6 offset:16896
    ds_read_b64_tr_b16 v[204:205], v6 offset:24576
    ds_read_b64_tr_b16 v[206:207], v6 offset:25088
    ds_read_b64_tr_b16 v[208:209], v6 offset:32768
    ds_read_b64_tr_b16 v[210:211], v6 offset:33280
    ds_read_b64_tr_b16 v[212:213], v6 offset:40960
    ds_read_b64_tr_b16 v[214:215], v6 offset:41472
    ds_read_b64_tr_b16 v[216:217], v6 offset:49152
    ds_read_b64_tr_b16 v[218:219], v6 offset:49664
    ds_read_b64_tr_b16 v[220:221], v6 offset:57344
    ds_read_b64_tr_b16 v[222:223], v6 offset:57856
    ds_read_b64_tr_b16 v[224:225], v4 offset:0
    ds_read_b64_tr_b16 v[226:227], v4 offset:512
    ds_read_b64_tr_b16 v[228:229], v4 offset:8192
    ds_read_b64_tr_b16 v[230:231], v4 offset:8704
    ds_read_b64_tr_b16 v[232:233], v4 offset:16384
    ds_read_b64_tr_b16 v[234:235], v4 offset:16896
    ds_read_b64_tr_b16 v[236:237], v4 offset:24576
    ds_read_b64_tr_b16 v[238:239], v4 offset:25088
    ds_read_b64_tr_b16 v[240:241], v4 offset:32768
    ds_read_b64_tr_b16 v[242:243], v4 offset:33280
    ds_read_b64_tr_b16 v[244:245], v4 offset:40960
    ds_read_b64_tr_b16 v[246:247], v4 offset:41472
    ds_read_b64_tr_b16 v[248:249], v4 offset:49152
    ds_read_b64_tr_b16 v[250:251], v4 offset:49664
    ds_read_b64_tr_b16 v[252:253], v4 offset:57344
    ds_read_b64_tr_b16 v[254:255], v4 offset:57856
    s_waitcnt lgkmcnt(0)
    s_cmp_lg_u32 s99, 1
    s_cbranch_scc1 L_a_z1
    v_mov_b32 v224, 0
    v_mov_b32 v225, 0
    v_mov_b32 v226, 0
    v_mov_b32 v227, 0
    v_mov_b32 v228, 0
    v_mov_b32 v229, 0
    v_mov_b32 v230, 0
    v_mov_b32 v231, 0
    v_mov_b32 v232, 0
    v_mov_b32 v233, 0
    v_mov_b32 v234, 0
    v_mov_b32 v235, 0
    v_mov_b32 v236, 0
    v_mov_b32 v237, 0
    v_mov_b32 v238, 0
    v_mov_b32 v239, 0
    v_mov_b32 v240, 0
    v_mov_b32 v241, 0
    v_mov_b32 v242, 0
    v_mov_b32 v243, 0
    v_mov_b32 v244, 0
    v_mov_b32 v245, 0
    v_mov_b32 v246, 0
    v_mov_b32 v247, 0
    v_mov_b32 v248, 0
    v_mov_b32 v249, 0
    v_mov_b32 v250, 0
    v_mov_b32 v251, 0
    v_mov_b32 v252, 0
    v_mov_b32 v253, 0
    v_mov_b32 v254, 0
    v_mov_b32 v255, 0
L_a_z1:
    s_cmp_lg_u32 s99, 2
    s_cbranch_scc1 L_a_z2
    v_mov_b32 v192, 0
    v_mov_b32 v193, 0
    v_mov_b32 v194, 0
    v_mov_b32 v195, 0
    v_mov_b32 v196, 0
    v_mov_b32 v197, 0
    v_mov_b32 v198, 0
    v_mov_b32 v199, 0
    v_mov_b32 v200, 0
    v_mov_b32 v201, 0
    v_mov_b32 v202, 0
    v_mov_b32 v203, 0
    v_mov_b32 v204, 0
    v_mov_b32 v205, 0
    v_mov_b32 v206, 0
    v_mov_b32 v207, 0
    v_mov_b32 v208, 0
    v_mov_b32 v209, 0
    v_mov_b32 v210, 0
    v_mov_b32 v211, 0
    v_mov_b32 v212, 0
    v_mov_b32 v213, 0
    v_mov_b32 v214, 0
    v_mov_b32 v215, 0
    v_mov_b32 v216, 0
    v_mov_b32 v217, 0
    v_mov_b32 v218, 0
    v_mov_b32 v219, 0
    v_mov_b32 v220, 0
    v_mov_b32 v221, 0
    v_mov_b32 v222, 0
    v_mov_b32 v223, 0
L_a_z2:
    s_nop 1
    v_mfma_f32_16x16x32_bf16 v[100:103], v[192:195], v[96:99], 0
    v_mfma_f32_16x16x32_bf16 v[100:103], v[196:199], v[96:99], v[100:103]
    v_mfma_f32_16x16x32_bf16 v[100:103], v[200:203], v[96:99], v[100:103]
    v_mfma_f32_16x16x32_bf16 v[100:103], v[204:207], v[96:99], v[100:103]
    v_mfma_f32_16x16x32_bf16 v[100:103], v[208:211], v[96:99], v[100:103]
    v_mfma_f32_16x16x32_bf16 v[100:103], v[212:215], v[96:99], v[100:103]
    v_mfma_f32_16x16x32_bf16 v[100:103], v[216:219], v[96:99], v[100:103]
    v_mfma_f32_16x16x32_bf16 v[100:103], v[220:223], v[96:99], v[100:103]
    v_mfma_f32_16x16x32_bf16 v[100:103], v[224:227], v[96:99], v[100:103]
    v_mfma_f32_16x16x32_bf16 v[100:103], v[228:231], v[96:99], v[100:103]
    v_mfma_f32_16x16x32_bf16 v[100:103], v[232:235], v[96:99], v[100:103]
    v_mfma_f32_16x16x32_bf16 v[100:103], v[236:239], v[96:99], v[100:103]
    v_mfma_f32_16x16x32_bf16 v[100:103], v[240:243], v[96:99], v[100:103]
    v_mfma_f32_16x16x32_bf16 v[100:103], v[244:247], v[96:99], v[100:103]
    v_mfma_f32_16x16x32_bf16 v[100:103], v[248:251], v[96:99], v[100:103]
    v_mfma_f32_16x16x32_bf16 v[100:103], v[252:255], v[96:99], v[100:103]
    s_nop 7
    v_permlane32_swap_b32 v100, v102
    v_permlane32_swap_b32 v101, v103
    s_nop 1
    v_add_f32_dpp v100, v102, v100 row_shl:8 row_mask:0xf bank_mask:0xf
    v_add_f32_dpp v101, v103, v101 row_shl:8 row_mask:0xf bank_mask:0xf
    s_cbranch_execz L_bell_50_ok
L_bell_50:
    s_mov_b64 exec, 1
    buffer_load_dword v9, v18, s[36:39], s86 offen offset:12 sc1
    s_waitcnt vmcnt(0)
    v_cmpx_eq_u32 vcc, s31, v9
    s_cbranch_execnz L_bell_50_ok
    s_sleep 1
    s_sub_u32 s52, s52, 1
    s_cbranch_scc0 L_bell_50
    s_mov_b32 s52, 0
L_bell_50_ok:
    s_mov_b64 exec, s[94:95]
L_poll_51:
    s_cbranch_execz L_poll_51_nl
    buffer_load_dwordx4 v[32:35], v18, s[36:39], s86 offen offset:0 sc1
    buffer_load_dwordx4 v[36:39], v18, s[36:39], s86 offen offset:1024 sc1
    buffer_load_dwordx4 v[40:43], v18, s[36:39], s86 offen offset:2048 sc1
    buffer_load_dwordx4 v[44:47], v18, s[36:39], s86 offen offset:3072 sc1
    s_waitcnt vmcnt(0)
L_poll_51_nl:
    v_cmpx_eq_u64 vcc, s[48:49], v[34:35]
    v_cmpx_eq_u64 vcc, s[48:49], v[38:39]
    v_cmpx_eq_u64 vcc, s[48:49], v[42:43]
    v_cmpx_eq_u64 vcc, s[48:49], v[46:47]
    s_cmp_eq_u64 exec, s[94:95]
    s_mov_b64 exec, s[94:95]
    s_cbranch_scc1 L_poll_51_ok
    s_sub_u32 s52, s52, 1
    s_cbranch_scc0 L_poll_51
    s_mov_b32 s52, 0
L_poll_51_ok:
    ds_write_b64 v17, v[32:33] offset:0
    ds_write_b64 v17, v[36:37] offset:4096
    ds_write_b64 v17, v[40:41] offset:8192
    ds_write_b64 v17, v[44:45] offset:12288
    v_dot2_f32_bf16 v31, v32, v96, 0
    v_dot2_f32_bf16 v30, v32, v32, 0
    v_dot2_f32_bf16 v31, v33, v96, v31
    v_dot2_f32_bf16 v30, v33, v33, v30
    v_dot2_f32_bf16 v31, v36, v96, v31
    v_dot2_f32_bf16 v30, v36, v36, v30
    v_dot2_f32_bf16 v31, v37, v96, v31
    v_dot2_f32_bf16 v30, v37, v37, v30
    v_dot2_f32_bf16 v31, v40, v96, v31
    v_dot2_f32_bf16 v30, v40, v40, v30
    v_dot2_f32_bf16 v31, v41, v96, v31
    v_dot2_f32_bf16 v30, v41, v41, v30
    v_dot2_f32_bf16 v31, v44, v96, v31
    v_dot2_f32_bf16 v30, v44, v44, v30
    v_dot2_f32_bf16 v31, v45, v96, v31
    v_dot2_f32_bf16 v30, v45, v45, v30
    s_waitcnt lgkmcnt(0)
    s_cbranch_execz L_nb_52
    s_barrier
L_nb_52:
    ds_read_b128 v[128:131], v7 offset:0
    ds_read_b128 v[132:135], v7 offset:1024
    ds_read_b128 v[136:139], v7 offset:2048
    ds_read_b128 v[140:143], v7 offset:3072
    ds_read_b128 v[144:147], v7 offset:4096
    ds_read_b128 v[148:151], v7 offset:5120
    ds_read_b128 v[152:155], v7 offset:6144
    ds_read_b128 v[156:159], v7 offset:7168
    ds_read_b128 v[160:163], v7 offset:8192
    ds_read_b128 v[164:167], v7 offset:9216
    ds_read_b128 v[168:171], v7 offset:10240
    ds_read_b128 v[172:175], v7 offset:11264
    ds_read_b128 v[176:179], v7 offset:12288
    ds_read_b128 v[180:183], v7 offset:13312
    ds_read_b128 v[184:187], v7 offset:14336
    ds_read_b128 v[188:191], v7 offset:15360
    s_nop 2
    v_add_f32_dpp v31, v31, v31 row_ror:8 row_mask:0xf bank_mask:0xf
    v_add_f32_dpp v30, v30, v30 row_ror:8 row_mask:0xf bank_mask:0xf
    s_nop 0
    v_add_f32_dpp v31, v31, v31 row_ror:4 row_mask:0xf bank_mask:0xf
    v_add_f32_dpp v30, v30, v30 row_ror:4 row_mask:0xf bank_mask:0xf
    s_nop 0
    v_add_f32_dpp v31, v31, v31 row_ror:2 row_mask:0xf bank_mask:0xf
    v_add_f32_dpp v30, v30, v30 row_ror:2 row_mask:0xf bank_mask:0xf
    s_nop 0
    v_add_f32_dpp v31, v31, v31 row_ror:1 row_mask:0xf bank_mask:0xf
    v_add_f32_dpp v30, v30, v30 row_ror:1 row_mask:0xf bank_mask:0xf
    s_nop 0
    s_nop 0
    v_permlane32_swap_b32 v31, v30
    s_nop 0
    v_add_f32 v31, v31, v30
    v_mov_b32 v30, v31
    s_nop 1
    v_permlane16_swap_b32 v31, v30
    s_nop 0
    v_add_f32 v31, v31, v30
    v_mov_b32 v30, v31
    s_waitcnt lgkmcnt(14)
    v_mfma_f32_16x16x32_bf16 v[20:23], v[192:195], v[128:131], 0
    v_permlane32_swap_b32 v31, v30
    v_mfma_f32_16x16x32_bf16 v[20:23], v[196:199], v[132:135], v[20:23]
    v_mul_f32 v28, 0x3a800000, v31
    v_mul_f32 v30, 0x3a800000, v30
    s_waitcnt lgkmcnt(12)
    v_mfma_f32_16x16x32_bf16 v[20:23], v[200:203], v[136:139], v[20:23]
    v_fma_f32 v30, -v28, v28, v30
    v_max_f32 v30, 0, v30
    v_mfma_f32_16x16x32_bf16 v[20:23], v[204:207], v[140:143], v[20:23]
    v_cvt_pk_bf16_f32 v30, v30, v30
    v_lshlrev_b32 v30, 16, v30
    s_waitcnt lgkmcnt(10)
    v_mfma_f32_16x16x32_bf16 v[20:23], v[208:211], v[144:147], v[20:23]
    v_add_f32 v30, 0x3727c5ac, v30
    v_cvt_pk_bf16_f32 v30, v30, v30
    v_mfma_f32_16x16x32_bf16 v[20:23], v[212:215], v[148:151], v[20:23]
    v_lshlrev_b32 v30, 16, v30
    v_sqrt_f32 v30, v30
    s_waitcnt lgkmcnt(8)
    v_mfma_f32_16x16x32_bf16 v[20:23], v[216:219], v[152:155], v[20:23]
    v_cvt_pk_bf16_f32 v28, v28, v28
    v_lshlrev_b32 v28, 16, v28
    v_mfma_f32_16x16x32_bf16 v[20:23], v[220:223], v[156:159], v[20:23]
    v_cvt_pk_bf16_f32 v30, v30, v30
    v_lshlrev_b32 v30, 16, v30
    s_waitcnt lgkmcnt(6)
    v_mfma_f32_16x16x32_bf16 v[20:23], v[224:227], v[160:163], v[20:23]
    v_rcp_f32 v29, v30
    v_mfma_f32_16x16x32_bf16 v[20:23], v[228:231], v[164:167], v[20:23]
    ds_write_b64 v14, v[28:29]
    s_waitcnt lgkmcnt(5)
    v_mfma_f32_16x16x32_bf16 v[20:23], v[232:235], v[168:171], v[20:23]
    v_mfma_f32_16x16x32_bf16 v[20:23], v[236:239], v[172:175], v[20:23]
    s_waitcnt lgkmcnt(0)
    s_cbranch_execz L_nb_53
    s_barrier
L_nb_53:
    ds_read_b64 v[28:29], v8
    v_mfma_f32_16x16x32_bf16 v[20:23], v[240:243], v[176:179], v[20:23]
    v_mfma_f32_16x16x32_bf16 v[20:23], v[244:247], v[180:183], v[20:23]
    v_mfma_f32_16x16x32_bf16 v[20:23], v[248:251], v[184:187], v[20:23]
    v_mfma_f32_16x16x32_bf16 v[20:23], v[252:255], v[188:191], v[20:23]
    s_waitcnt lgkmcnt(0)
    v_mul_f32 v9, v28, v29
    v_mul_f32 v10, v9, v100
    v_mul_f32 v11, v9, v101
    s_nop 3
    v_permlane32_swap_b32 v20, v22
    v_permlane32_swap_b32 v21, v23
    s_nop 1
    v_add_f32_dpp v20, v22, v20 row_shl:8 row_mask:0xf bank_mask:0xf
    v_add_f32_dpp v21, v23, v21 row_shl:8 row_mask:0xf bank_mask:0xf
    v_fma_f32 v20, v20, v29, -v10
    v_fma_f32 v21, v21, v29, -v11
    s_cmp_lg_u32 s99, 0
    s_cbranch_scc1 L_a_part
    v_cvt_pk_bf16_f32 v24, v20, v21
    s_cmp_lg_u32 s96, 0
    s_cbranch_scc1 L_nosig_54
    v_lshlrev_b32 v64, 16, v24
    v_and_b32 v65, 0xffff0000, v24
    v_mul_f32 v64, 0xbfb8aa3b, v64
    v_mul_f32 v65, 0xbfb8aa3b, v65
    v_exp_f32 v64, v64
    v_exp_f32 v65, v65
    s_nop 0
    v_add_f32 v64, 1.0, v64
    v_add_f32 v65, 1.0, v65
    v_rcp_f32 v64, v64
    v_rcp_f32 v65, v65
    s_nop 0
    v_cvt_pk_bf16_f32 v24, v64, v65
L_nosig_54:
    s_andn2_b64 exec, s[62:63], s[50:51]
    s_cbranch_execz L_ns_55
    buffer_store_dwordx2 v[24:25], v13, s[36:39], s85 offen
L_ns_55:
    s_andn2_b64 exec, s[92:93], s[50:51]
    s_cbranch_execz L_ns_56
    buffer_store_dwordx2 v[24:25], v13, s[36:39], s85 offen sc1
L_ns_56:
    s_mov_b64 exec, s[94:95]
    s_branch L_a_pubd
L_a_part:
    v_mov_b32 v24, v20
    v_mov_b32 v25, v21
    s_andn2_b64 exec, s[62:63], s[50:51]
    s_cbranch_execz L_ns_57
    buffer_store_dwordx4 v[24:27], v15, s[36:39], s84 offen
L_ns_57:
    s_andn2_b64 exec, s[92:93], s[50:51]
    s_cbranch_execz L_ns_58
    buffer_store_dwordx4 v[24:27], v15, s[36:39], s84 offen sc1
L_ns_58:
    s_mov_b64 exec, s[94:95]
L_a_pubd:
    s_cmp_lg_u32 s59, 0
    s_cbranch_scc1 L_a_gureal
L_a_done:
    s_endpgm
L_a_idle:
    s_cmp_lg_u32 s28, 0
    s_cbranch_scc1 L_nt2_59
    s_lshl_b32 s53, s30, 3
    s_or_b32 s53, s53, s29
    s_lshl_b32 s53, s53, 7
    s_add_u32 s53, s53, 0x4000
    s_and_b64 exec, s[94:95], 1
    s_cbranch_execz L_ns_60
    buffer_store_dword v27, v19, s[36:39], s53 offen offset:8 sc1
L_ns_60:
    s_mov_b64 exec, s[94:95]
L_nt2_59:
    s_branch L_a_done
L_end:
    s_endpgm
.section .rodata,"a"
.p2align 6
.amdhsa_kernel sequential_preLN__sliding_block_cached__glu_gated_glu__decode_kernel
  .amdhsa_next_free_vgpr 256
  .amdhsa_next_free_sgpr 102
  .amdhsa_accum_offset 256
  .amdhsa_group_segment_fixed_size 0
  .amdhsa_kernarg_size 96
  .amdhsa_user_sgpr_count 2
  .amdhsa_user_sgpr_kernarg_segment_ptr 1
  .amdhsa_system_sgpr_workgroup_id_x 1
.end_amdhsa_kernel
```
